```python
import torch

def _softmax(x, axis=-1):
    return torch.softmax(x, dim=axis)
def _gelu(x):
    return torch.nn.functional.gelu(x, approximate="tanh")
def _silu(x):
    return torch.nn.functional.silu(x)
def _sigmoid(x):
    return torch.sigmoid(x)
def _layernorm(x, axis=-1, eps=1e-5):
    m = x.mean(dim=axis, keepdim=True)
    v = x.var(dim=axis, keepdim=True, unbiased=False)
    return (x - m) / torch.sqrt(v + eps)
def _scatter_add(tgt, idx, src, axis=0):
    return tgt.clone().index_add_(axis, idx, src)
def _segment_sum(src, seg, n):
    out = torch.zeros((n,) + src.shape[1:], dtype=src.dtype)
    return out.index_add_(0, seg, src)
def _pad(x, pw):
    flat = tuple(v for pair in reversed(pw) for v in pair)
    return torch.nn.functional.pad(x, flat)

kernel_name = 'standalone__self_sup_conv_stem_wavlm__speech'

def setup_inputs():

    _w = (lambda a: (lambda t: t.to(torch.bfloat16) if t.is_floating_point() else t)(torch.as_tensor(a)))
    B, T, D, K = 2, 16000, 144, 15
    scale = (K * D) ** -0.5
    return {
        "x": _w((lambda *s: torch.randn(*s, dtype=torch.bfloat16) * 0.05)(B, T, D)),
        "w": _w((lambda *s: torch.randn(*s, dtype=torch.bfloat16) * 0.05)(K, D, D) * scale),
        "gn_gamma": _w((lambda *s: torch.randn(*s, dtype=torch.bfloat16) * 0.05)(D) * 0.1 + 1.0),
        "gn_beta": _w((lambda *s: torch.randn(*s, dtype=torch.bfloat16) * 0.05)(D) * 0.1),
    }

def reference(x, w, gn_gamma, gn_beta):
    B, T, D = x.shape
    K = w.shape[0]
    s = 2
    L = (T - K) // s + 1
    h = torch.einsum('blc,cd->bld', x[:, 0:s * L:s, :], w[0])
    for i in range(1, K):
        h = h + torch.einsum('blc,cd->bld', x[:, i:i + s * L:s, :], w[i])
    mu = torch.einsum('bld->bd', h)[:, None, :] / L
    var = torch.einsum('bld->bd', (h - mu) ** 2)[:, None, :] / L
    h = (h - mu) / torch.sqrt(var + 1e-5)
    h = h * gn_gamma[None, None, :] + gn_beta[None, None, :]
    return _gelu(h)
```

```asm
; @launch grid=(252,1,1) block=(512,1,1) lds=163840
.amdgcn_target "amdgcn-amd-amdhsa--gfx950"
.text
.globl standalone__self_sup_conv_stem_wavlm__speech_kernel
.p2align 12
.p2align 8
.type standalone__self_sup_conv_stem_wavlm__speech_kernel,@function
standalone__self_sup_conv_stem_wavlm__speech_kernel:
  s_load_dwordx8 s[4:11], s[0:1], 0
  s_load_dwordx4 s[12:15], s[0:1], 32
  s_load_dwordx2 s[16:17], s[0:1], 48
  v_lshrrev_b32 v2, 6, v0
  v_and_b32 v1, 63, v0
  s_cmp_ge_u32 s2, 252
  s_cbranch_scc1 L_end
  s_and_b32 s60, s2, 7
  s_lshr_b32 s61, s2, 3
  v_readfirstlane_b32 s20, v2
  s_getpc_b64 s[68:69]
L_pc:
  v_lshlrev_b32 v4, 1, v0
  s_lshl_b32 s62, s61, 10
  v_add_u32 v4, s62, v4
  v_min_u32 v4, L_codeend - L_pc - 4, v4
  s_mov_b64 exec, 1
  global_load_dword v188, v4, s[68:69]
  s_mov_b64 exec, -1
  s_mul_i32 s21, s61, 43
  s_lshr_b32 s21, s21, 7
  s_mul_i32 s63, s21, 3
  s_sub_u32 s22, s61, s63
  s_lshl_b32 s21, s21, 3
  s_add_u32 s21, s21, s60
  s_cmp_ge_u32 s21, 84
  s_cselect_b32 s22, 2, s22
  s_cselect_b32 s62, 4, 0
  s_sub_u32 s21, s21, s62
  s_cmp_ge_u32 s21, 42
  s_cselect_b32 s63, 4608000, 0
  s_cselect_b32 s62, 42, 0
  s_sub_u32 s24, s21, s62
  s_mul_i32 s62, s24, 110592
  v_lshrrev_b32 v3, 3, v1
  v_and_b32 v4, 7, v1
  v_and_b32 v5, 2, v3
  v_xor_b32 v4, v4, v5
  v_lshlrev_b32 v4, 4, v4
  v_mul_u32_u24 v3, 1152, v3
  v_add3_u32 v2, v3, v4, s62
  s_mul_i32 s62, s22, 9216
  v_add_u32 v3, s62, v2
  s_lshl_b32 s18, s22, 10
  s_and_b32 s64, s20, 3
  s_cmp_ge_u32 s20, 4
  s_cselect_b32 s65, 51200, 0
  s_cselect_b32 s66, 512, 0
  s_mul_i32 s82, s64, 3072
  s_add_u32 s82, s82, s65
  s_mul_i32 s83, s64, 27648
  s_add_u32 s83, s83, s66
  s_mov_b32 s31, 0x20000
  s_mov_b32 s30, 4608000
  s_add_u32 m0, s82, s18
  s_mov_b32 s56, -1
  s_mov_b32 s57, 0
  s_cmp_ge_u32 s21, 42
  s_cselect_b32 s23, 1, 0
  s_mul_i32 s26, s22, 96
  s_add_u32 s3, s26, 2048
  s_mov_b32 s35, 0x20000
  s_mov_b32 s34, 624128
  s_mul_i32 s25, s20, 43
  s_lshr_b32 s25, s25, 7
  s_mul_i32 s25, s25, 3
  s_sub_u32 s25, s20, s25
  s_lshl_b32 s62, s25, 6
  v_add_u32 v5, s62, v1
  v_mul_u32_u24 v6, 171, v5
  v_lshrrev_b32 v6, 10, v6
  v_mul_u32_u24 v7, 6, v6
  v_sub_u32 v7, v5, v7
  v_and_b32 v8, 0x13, v6
  v_and_b32 v9, 4, v6
  v_lshl_or_b32 v8, v9, 1, v8
  v_and_b32 v9, 8, v6
  v_lshrrev_b32 v9, 1, v9
  v_or_b32 v8, v8, v9
  v_mul_u32_u24 v8, 288, v8
  v_lshlrev_b32 v7, 4, v7
  v_add3_u32 v13, v8, v7, s3
  s_lshl_b32 s67, s25, 10
  s_waitcnt lgkmcnt(0)
  s_add_u32 s28, s4, s63
  s_addc_u32 s29, s5, 0
  s_sub_u32 s32, s6, 2048
  s_subb_u32 s33, s7, 0
  buffer_load_dwordx4 v3, s[28:31], s83 offen lds
  s_cmp_lg_u32 s64, 0
  s_cbranch_scc1 L_st1
  s_add_u32 m0, s65, 12288
  s_add_u32 s62, s66, 110592
  s_mov_b64 exec, s[56:57]
  buffer_load_dwordx4 v2, s[28:31], s62 offen lds
  s_mov_b64 exec, -1
L_st1:
  s_cmp_ge_u32 s20, 3
  s_cbranch_scc1 L_st2
  s_lshl_b32 s62, s20, 10
  s_add_u32 m0, s62, 115200
  s_nop 0
  buffer_load_dwordx4 v13, s[32:35], 0 offen lds
  s_branch L_st3
L_st2:
  s_cmp_eq_u32 s20, 7
  s_cbranch_scc1 L_st2b
  s_sub_u32 s62, s20, 3
  s_mul_i32 s63, s62, 3072
  s_add_u32 s63, s63, s18
  s_add_u32 m0, s63, 64000
  s_mul_i32 s62, s62, 27648
  s_add_u32 s62, s62, 640
  buffer_load_dwordx4 v3, s[28:31], s62 offen lds
  s_branch L_st3
L_st2b:
  s_mov_b32 m0, 76288
  s_mov_b32 s62, 111232
  s_mov_b64 exec, s[56:57]
  buffer_load_dwordx4 v2, s[28:31], s62 offen lds
  s_mov_b64 exec, -1
L_st3:
  s_mul_i32 s62, s20, 31
  s_add_u32 s62, s62, s61
  s_lshr_b32 s63, s60, 2
  s_add_u32 s68, s63, 5
  s_lshr_b32 s69, s62, s68
  s_lshl_b32 s70, s69, s68
  s_sub_u32 s62, s62, s70
  s_lshr_b32 s70, s62, 3
  s_and_b32 s62, s62, 7
  s_lshr_b32 s71, s70, s63
  s_mul_i32 s71, s71, 3
  s_and_b32 s70, s70, s63
  s_add_u32 s71, s71, s70
  s_xor_b32 s63, s63, 1
  s_lshl_b32 s63, s63, 1
  s_add_u32 s71, s71, s63
  s_lshl_b32 s71, s71, 3
  s_add_u32 s62, s62, s71
  s_mul_i32 s62, s62, 1152
  s_lshl_b32 s70, s69, 2
  s_lshr_b32 s70, 1344, s70
  s_and_b32 s70, s70, 15
  s_lshl_b32 s70, s70, 7
  s_add_u32 s62, s62, s70
  s_and_b32 s21, s60, 3
  s_mul_i32 s21, s21, 110592
  s_add_u32 s21, s21, 8810496
  s_add_u32 s62, s62, s21
  s_cmp_ge_u32 s69, 3
  s_cselect_b32 s62, 9216000, s62
  s_mov_b32 s36, s4
  s_mov_b32 s37, s5
  s_mov_b32 s38, 9216000
  s_mov_b32 s39, 0x20000
  s_mov_b64 exec, 1
  buffer_load_dword v190, off, s[36:39], s62
  s_mov_b64 exec, -1
  s_mul_i32 s62, s20, 155
  s_add_u32 s62, s62, s61
  v_mul_u32_u24 v7, 31, v1
  v_add_u32 v7, s62, v7
  v_mul_u32_u24 v8, 911, v7
  v_lshrrev_b32 v8, 16, v8
  v_mul_u32_u24 v9, 72, v8
  v_sub_u32 v9, v7, v9
  v_lshrrev_b32 v7, 3, v8
  v_and_b32 v8, 7, v8
  v_mul_u32_u24 v7, 72, v7
  v_add_u32 v9, v9, v7
  v_mul_u32_u24 v8, 648, v8
  v_add_u32 v9, v9, v8
  v_lshlrev_b32 v9, 7, v9
  s_mov_b64 exec, 31
  buffer_load_dword v189, v9, s[32:35], 0 offen offset:2048 sc1
  s_mov_b64 exec, -1
  s_add_u32 s62, s22, 1
  s_cmp_eq_u32 s22, 2
  s_cselect_b32 s62, 0, s62
  s_sub_u32 s63, 3, s22
  s_sub_u32 s63, s63, s62
  s_lshl_b32 s19, s62, 10
  s_lshl_b32 s27, s63, 10
  s_mul_i32 s62, s62, 9216
  s_mul_i32 s63, s63, 9216
  v_add_u32 v14, s62, v2
  v_add_u32 v15, s63, v2
  s_add_u32 m0, s82, s19
  s_cmp_ge_u32 s20, 4
  s_cbranch_scc1 L_nocalc
  v_and_b32 v4, 15, v1
  v_lshrrev_b32 v5, 4, v1
  v_mul_u32_u24 v6, 3, v4
  s_mul_i32 s62, s20, 48
  v_add_u32 v6, s62, v6
  v_add_u32 v7, 0, v6
  v_lshrrev_b32 v8, 1, v7
  v_and_b32 v9, 1, v7
  v_lshl_or_b32 v10, v9, 2, v5
  v_and_b32 v11, 2, v8
  v_xor_b32 v10, v10, v11
  v_lshlrev_b32 v10, 4, v10
  v_lshl_add_u32 v10, v8, 7, v10
  v_mul_u32_u24 v11, 12800, v9
  v_lshl_add_u32 v16, v11, 2, v10
  v_xor_b32 v12, 64, v16
  v_add_u32 v24, v12, v11
  v_xor_b32 v12, 32, v16
  v_add_u32 v20, 256, v12
  v_xor_b32 v12, 32, v24
  v_add_u32 v28, 256, v12
  v_add_u32 v7, 1, v6
  v_lshrrev_b32 v8, 1, v7
  v_and_b32 v9, 1, v7
  v_lshl_or_b32 v10, v9, 2, v5
  v_and_b32 v11, 2, v8
  v_xor_b32 v10, v10, v11
  v_lshlrev_b32 v10, 4, v10
  v_lshl_add_u32 v10, v8, 7, v10
  v_mul_u32_u24 v11, 12800, v9
  v_lshl_add_u32 v17, v11, 2, v10
  v_xor_b32 v12, 64, v17
  v_add_u32 v25, v12, v11
  v_xor_b32 v12, 32, v17
  v_add_u32 v21, 256, v12
  v_xor_b32 v12, 32, v25
  v_add_u32 v29, 256, v12
  v_add_u32 v7, 2, v6
  v_lshrrev_b32 v8, 1, v7
  v_and_b32 v9, 1, v7
  v_lshl_or_b32 v10, v9, 2, v5
  v_and_b32 v11, 2, v8
  v_xor_b32 v10, v10, v11
  v_lshlrev_b32 v10, 4, v10
  v_lshl_add_u32 v10, v8, 7, v10
  v_mul_u32_u24 v11, 12800, v9
  v_lshl_add_u32 v18, v11, 2, v10
  v_xor_b32 v12, 64, v18
  v_add_u32 v26, v12, v11
  v_xor_b32 v12, 32, v18
  v_add_u32 v22, 256, v12
  v_xor_b32 v12, 32, v26
  v_add_u32 v30, 256, v12
  v_add_u32 v7, 3, v6
  v_lshrrev_b32 v8, 1, v7
  v_and_b32 v9, 1, v7
  v_lshl_or_b32 v10, v9, 2, v5
  v_and_b32 v11, 2, v8
  v_xor_b32 v10, v10, v11
  v_lshlrev_b32 v10, 4, v10
  v_lshl_add_u32 v10, v8, 7, v10
  v_mul_u32_u24 v11, 12800, v9
  v_lshl_add_u32 v19, v11, 2, v10
  v_xor_b32 v12, 64, v19
  v_add_u32 v27, v12, v11
  v_xor_b32 v12, 32, v19
  v_add_u32 v23, 256, v12
  v_xor_b32 v12, 32, v27
  v_add_u32 v31, 256, v12
  s_mov_b64 vcc, s[56:57]
  v_lshrrev_b32 v7, 5, v1
  v_lshlrev_b32 v7, 4, v7
  v_and_b32 v8, 1, v5
  v_lshl_add_u32 v7, v8, 2, v7
  v_bfe_u32 v8, v1, 2, 2
  v_add_u32 v7, v7, v8
  v_mul_u32_u24 v7, 96, v7
  v_and_b32 v8, 3, v1
  v_mul_u32_u24 v8, 24, v8
  v_add_u32 v7, v7, v8
  v_add_u32 v32, 115200, v7
  v_mov_b32 v7, 118784
  v_cndmask_b32 v52, v7, v23, vcc
  v_cndmask_b32 v53, v7, v16, vcc
  v_cndmask_b32 v54, v7, v17, vcc
  v_lshlrev_b32 v33, 5, v5
  v_lshrrev_b32 v7, 2, v4
  v_lshl_add_u32 v33, v7, 2, v33
  s_mul_i32 s62, s20, 384
  s_add_u32 s62, s62, 161280
  v_add_u32 v33, s62, v33
  s_lshl_b32 s62, s20, 2
  s_add_u32 s62, s62, 163200
  v_mov_b32 v34, s62
  v_mov_b32 v35, 1
  s_movk_i32 s62, 121
  v_cmp_le_u32 s[40:41], s62, v6
  s_movk_i32 s62, 120
  v_cmp_le_u32 s[42:43], s62, v6
  s_movk_i32 s62, 119
  v_cmp_le_u32 s[44:45], s62, v6
L_nocalc:
  s_barrier
  buffer_load_dwordx4 v14, s[28:31], s83 offen lds
  s_add_u32 m0, s82, s27
  s_cmp_lt_u32 s20, 4
  buffer_load_dwordx4 v15, s[28:31], s83 offen lds
  s_cbranch_scc1 L_comp
  s_mul_i32 s25, s23, 3
  s_add_u32 s25, s25, s22
  s_cmp_ge_u32 s20, 6
  s_cbranch_scc1 L_ew
  s_mov_b32 s62, s67
  s_add_u32 m0, s62, 118272
  s_mov_b32 s63, 82944
  buffer_load_dwordx4 v13, s[32:35], s63 offen lds
  s_add_u32 m0, s62, 121344
  s_mov_b32 s63, 165888
  buffer_load_dwordx4 v13, s[32:35], s63 offen lds
  s_cmp_eq_u32 s20, 5
  s_cbranch_scc1 L_x5
  s_branch L_x4
L_ew:
  s_cmp_eq_u32 s20, 7
  s_cbranch_scc1 L_ew7
  s_mov_b32 m0, 118272
  s_mov_b32 s62, 82944
  buffer_load_dwordx4 v13, s[32:35], s62 offen lds
  s_mov_b32 m0, 121344
  s_mov_b32 s62, 165888
  buffer_load_dwordx4 v13, s[32:35], s62 offen lds
  v_mov_b32 v10, v13
  s_add_u32 s62, s26, 1024
  v_add_u32 v5, 64, v1
  v_mul_u32_u24 v6, 171, v5
  v_lshrrev_b32 v6, 10, v6
  v_mul_u32_u24 v7, 6, v6
  v_sub_u32 v7, v5, v7
  v_and_b32 v8, 0x13, v6
  v_and_b32 v9, 4, v6
  v_lshl_or_b32 v8, v9, 1, v8
  v_and_b32 v9, 8, v6
  v_lshrrev_b32 v9, 1, v9
  v_or_b32 v8, v8, v9
  v_mul_u32_u24 v8, 288, v8
  v_lshlrev_b32 v7, 4, v7
  v_add3_u32 v11, v8, v7, s62
  v_add_u32 v5, 128, v1
  v_mul_u32_u24 v6, 171, v5
  v_lshrrev_b32 v6, 10, v6
  v_mul_u32_u24 v7, 6, v6
  v_sub_u32 v7, v5, v7
  v_and_b32 v8, 0x13, v6
  v_and_b32 v9, 4, v6
  v_lshl_or_b32 v8, v9, 1, v8
  v_and_b32 v9, 8, v6
  v_lshrrev_b32 v9, 1, v9
  v_or_b32 v8, v8, v9
  v_mul_u32_u24 v8, 288, v8
  v_lshlrev_b32 v7, 4, v7
  v_add3_u32 v12, v8, v7, s26
  s_mov_b32 m0, 124416
  s_mov_b32 s62, 248832
  buffer_load_dwordx4 v10, s[32:35], s62 offen offset:0 lds
  buffer_load_dwordx4 v11, s[32:35], s62 offen offset:1024 lds
  buffer_load_dwordx4 v12, s[32:35], s62 offen offset:2048 lds
  s_mov_b32 m0, 130560
  s_mov_b32 s62, 414720
  buffer_load_dwordx4 v10, s[32:35], s62 offen offset:0 lds
  buffer_load_dwordx4 v11, s[32:35], s62 offen offset:1024 lds
  buffer_load_dwordx4 v12, s[32:35], s62 offen offset:2048 lds
  s_mov_b32 m0, 136704
  s_mov_b32 s62, 580608
  buffer_load_dwordx4 v10, s[32:35], s62 offen offset:0 lds
  buffer_load_dwordx4 v11, s[32:35], s62 offen offset:1024 lds
  buffer_load_dwordx4 v12, s[32:35], s62 offen offset:2048 lds
  s_branch L_w6
L_ew7:
  v_subrev_u32 v11, 1024, v13
  v_mul_u32_u24 v6, 171, v1
  v_lshrrev_b32 v6, 10, v6
  v_mul_u32_u24 v7, 6, v6
  v_sub_u32 v7, v1, v7
  v_and_b32 v8, 0x13, v6
  v_and_b32 v9, 4, v6
  v_lshl_or_b32 v8, v9, 1, v8
  v_and_b32 v9, 8, v6
  v_lshrrev_b32 v9, 1, v9
  v_or_b32 v8, v8, v9
  v_mul_u32_u24 v8, 288, v8
  v_lshlrev_b32 v7, 4, v7
  v_add3_u32 v10, v8, v7, s3
  v_add_u32 v5, 128, v1
  v_mul_u32_u24 v6, 171, v5
  v_lshrrev_b32 v6, 10, v6
  v_mul_u32_u24 v7, 6, v6
  v_sub_u32 v7, v5, v7
  v_and_b32 v8, 0x13, v6
  v_and_b32 v9, 4, v6
  v_lshl_or_b32 v8, v9, 1, v8
  v_and_b32 v9, 8, v6
  v_lshrrev_b32 v9, 1, v9
  v_or_b32 v8, v8, v9
  v_mul_u32_u24 v8, 288, v8
  v_lshlrev_b32 v7, 4, v7
  v_add3_u32 v12, v8, v7, s26
  s_mov_b32 m0, 127488
  s_mov_b32 s62, 331776
  buffer_load_dwordx4 v10, s[32:35], s62 offen offset:0 lds
  buffer_load_dwordx4 v11, s[32:35], s62 offen offset:1024 lds
  buffer_load_dwordx4 v12, s[32:35], s62 offen offset:2048 lds
  s_mov_b32 m0, 133632
  s_mov_b32 s62, 497664
  buffer_load_dwordx4 v10, s[32:35], s62 offen offset:0 lds
  buffer_load_dwordx4 v11, s[32:35], s62 offen offset:1024 lds
  buffer_load_dwordx4 v12, s[32:35], s62 offen offset:2048 lds
  s_mov_b32 m0, 139776
  s_mov_b32 s62, 9216
  buffer_load_dwordx4 v10, s[32:35], s62 offen offset:0 lds
  buffer_load_dwordx4 v11, s[32:35], s62 offen offset:1024 lds
  buffer_load_dwordx4 v12, s[32:35], s62 offen offset:2048 lds
  v_lshlrev_b32 v4, 2, v1
  v_add_u32 v4, 163200, v4
  v_mov_b32 v5, 0
  s_mov_b64 exec, s[56:57]
  ds_write_b32 v4, v5
  s_mov_b64 exec, -1
  s_waitcnt lgkmcnt(0)
  s_branch L_w7
L_comp:
  s_mov_b64 exec, 0
  s_cmp_eq_u32 s20, 3
  s_cbranch_scc1 L_gh
  s_cmp_eq_u32 s20, 2
  s_cbranch_scc1 L_hop2
  s_cmp_eq_u32 s20, 1
  s_cbranch_scc1 L_hop1
  s_branch L_hop0
L_wr:
  s_mov_b64 exec, -1
  s_waitcnt vmcnt(0) lgkmcnt(0)
  s_barrier
  ds_read_b64_tr_b16 v[140:141], v32 offset:0
  ds_read_b64_tr_b16 v[142:143], v32 offset:768
  ds_read_b128 v[100:103], v16 offset:0
  ds_read_b128 v[104:107], v17 offset:0
  ds_read_b128 v[108:111], v18 offset:0
  ds_read_b64_tr_b16 v[144:145], v32 offset:8
  ds_read_b64_tr_b16 v[146:147], v32 offset:776
  ds_read_b64_tr_b16 v[148:149], v32 offset:16
  ds_read_b64_tr_b16 v[150:151], v32 offset:784
  s_waitcnt lgkmcnt(6)
  v_mfma_f32_16x16x32_bf16 v[64:67], v[140:143], v[100:103], 0
  s_barrier
  ds_read_b64_tr_b16 v[152:153], v32 offset:3072
  s_waitcnt lgkmcnt(6)
  v_mfma_f32_16x16x32_bf16 v[76:79], v[140:143], v[104:107], 0
  ds_read_b64_tr_b16 v[154:155], v32 offset:3840
  s_waitcnt lgkmcnt(6)
  v_mfma_f32_16x16x32_bf16 v[88:91], v[140:143], v[108:111], 0
  ds_read_b128 v[112:115], v19 offset:0
  s_waitcnt lgkmcnt(5)
  v_mfma_f32_16x16x32_bf16 v[68:71], v[144:147], v[100:103], 0
  ds_read_b64_tr_b16 v[156:157], v32 offset:3080
  v_mfma_f32_16x16x32_bf16 v[80:83], v[144:147], v[104:107], 0
  ds_read_b64_tr_b16 v[158:159], v32 offset:3848
  v_mfma_f32_16x16x32_bf16 v[92:95], v[144:147], v[108:111], 0
  ds_read_b64_tr_b16 v[160:161], v32 offset:3088
  s_waitcnt lgkmcnt(6)
  v_mfma_f32_16x16x32_bf16 v[72:75], v[148:151], v[100:103], 0
  ds_read_b64_tr_b16 v[162:163], v32 offset:3856
  v_mfma_f32_16x16x32_bf16 v[84:87], v[148:151], v[104:107], 0
  v_mfma_f32_16x16x32_bf16 v[96:99], v[148:151], v[108:111], 0
  s_waitcnt lgkmcnt(5)
  v_mfma_f32_16x16x32_bf16 v[64:67], v[152:155], v[104:107], v[64:67]
  s_barrier
  ds_read_b64_tr_b16 v[140:141], v32 offset:6144
  v_mfma_f32_16x16x32_bf16 v[76:79], v[152:155], v[108:111], v[76:79]
  ds_read_b64_tr_b16 v[142:143], v32 offset:6912
  s_waitcnt lgkmcnt(6)
  v_mfma_f32_16x16x32_bf16 v[88:91], v[152:155], v[112:115], v[88:91]
  ds_read_b128 v[116:119], v20 offset:0
  s_waitcnt lgkmcnt(5)
  v_mfma_f32_16x16x32_bf16 v[68:71], v[156:159], v[104:107], v[68:71]
  ds_read_b64_tr_b16 v[144:145], v32 offset:6152
  v_mfma_f32_16x16x32_bf16 v[80:83], v[156:159], v[108:111], v[80:83]
  ds_read_b64_tr_b16 v[146:147], v32 offset:6920
  v_mfma_f32_16x16x32_bf16 v[92:95], v[156:159], v[112:115], v[92:95]
  ds_read_b64_tr_b16 v[148:149], v32 offset:6160
  s_waitcnt lgkmcnt(6)
  v_mfma_f32_16x16x32_bf16 v[72:75], v[160:163], v[104:107], v[72:75]
  ds_read_b64_tr_b16 v[150:151], v32 offset:6928
  v_mfma_f32_16x16x32_bf16 v[84:87], v[160:163], v[108:111], v[84:87]
  v_mfma_f32_16x16x32_bf16 v[96:99], v[160:163], v[112:115], v[96:99]
  s_waitcnt lgkmcnt(5)
  v_mfma_f32_16x16x32_bf16 v[64:67], v[140:143], v[108:111], v[64:67]
  s_barrier
  ds_read_b64_tr_b16 v[152:153], v32 offset:9216
  v_mfma_f32_16x16x32_bf16 v[76:79], v[140:143], v[112:115], v[76:79]
  ds_read_b64_tr_b16 v[154:155], v32 offset:9984
  s_waitcnt lgkmcnt(6)
  v_mfma_f32_16x16x32_bf16 v[88:91], v[140:143], v[116:119], v[88:91]
  ds_read_b128 v[120:123], v21 offset:0
  s_waitcnt lgkmcnt(5)
  v_mfma_f32_16x16x32_bf16 v[68:71], v[144:147], v[108:111], v[68:71]
  ds_read_b64_tr_b16 v[156:157], v32 offset:9224
  v_mfma_f32_16x16x32_bf16 v[80:83], v[144:147], v[112:115], v[80:83]
  ds_read_b64_tr_b16 v[158:159], v32 offset:9992
  v_mfma_f32_16x16x32_bf16 v[92:95], v[144:147], v[116:119], v[92:95]
  ds_read_b64_tr_b16 v[160:161], v32 offset:9232
  s_waitcnt lgkmcnt(6)
  v_mfma_f32_16x16x32_bf16 v[72:75], v[148:151], v[108:111], v[72:75]
  ds_read_b64_tr_b16 v[162:163], v32 offset:10000
  v_mfma_f32_16x16x32_bf16 v[84:87], v[148:151], v[112:115], v[84:87]
  v_mfma_f32_16x16x32_bf16 v[96:99], v[148:151], v[116:119], v[96:99]
  s_waitcnt lgkmcnt(5)
  v_mfma_f32_16x16x32_bf16 v[64:67], v[152:155], v[112:115], v[64:67]
  ds_read_b64_tr_b16 v[140:141], v32 offset:12288
  v_mfma_f32_16x16x32_bf16 v[76:79], v[152:155], v[116:119], v[76:79]
  ds_read_b64_tr_b16 v[142:143], v32 offset:13056
  s_waitcnt lgkmcnt(6)
  v_mfma_f32_16x16x32_bf16 v[88:91], v[152:155], v[120:123], v[88:91]
  ds_read_b128 v[124:127], v22 offset:0
  s_waitcnt lgkmcnt(5)
  v_mfma_f32_16x16x32_bf16 v[68:71], v[156:159], v[112:115], v[68:71]
  ds_read_b64_tr_b16 v[144:145], v32 offset:12296
  v_mfma_f32_16x16x32_bf16 v[80:83], v[156:159], v[116:119], v[80:83]
  ds_read_b64_tr_b16 v[146:147], v32 offset:13064
  v_mfma_f32_16x16x32_bf16 v[92:95], v[156:159], v[120:123], v[92:95]
  ds_read_b64_tr_b16 v[148:149], v32 offset:12304
  s_waitcnt lgkmcnt(6)
  v_mfma_f32_16x16x32_bf16 v[72:75], v[160:163], v[112:115], v[72:75]
  ds_read_b64_tr_b16 v[150:151], v32 offset:13072
  v_mfma_f32_16x16x32_bf16 v[84:87], v[160:163], v[116:119], v[84:87]
  v_mfma_f32_16x16x32_bf16 v[96:99], v[160:163], v[120:123], v[96:99]
  s_waitcnt lgkmcnt(5)
  v_mfma_f32_16x16x32_bf16 v[64:67], v[140:143], v[116:119], v[64:67]
  ds_read_b64_tr_b16 v[152:153], v32 offset:15360
  v_mfma_f32_16x16x32_bf16 v[76:79], v[140:143], v[120:123], v[76:79]
  ds_read_b64_tr_b16 v[154:155], v32 offset:16128
  s_waitcnt lgkmcnt(6)
  v_mfma_f32_16x16x32_bf16 v[88:91], v[140:143], v[124:127], v[88:91]
  ds_read_b128 v[128:131], v23 offset:0
  s_waitcnt lgkmcnt(5)
  v_mfma_f32_16x16x32_bf16 v[68:71], v[144:147], v[116:119], v[68:71]
  ds_read_b64_tr_b16 v[156:157], v32 offset:15368
  v_mfma_f32_16x16x32_bf16 v[80:83], v[144:147], v[120:123], v[80:83]
  ds_read_b64_tr_b16 v[158:159], v32 offset:16136
  v_mfma_f32_16x16x32_bf16 v[92:95], v[144:147], v[124:127], v[92:95]
  ds_read_b64_tr_b16 v[160:161], v32 offset:15376
  s_waitcnt lgkmcnt(6)
  v_mfma_f32_16x16x32_bf16 v[72:75], v[148:151], v[116:119], v[72:75]
  ds_read_b64_tr_b16 v[162:163], v32 offset:16144
  v_mfma_f32_16x16x32_bf16 v[84:87], v[148:151], v[120:123], v[84:87]
  v_mfma_f32_16x16x32_bf16 v[96:99], v[148:151], v[124:127], v[96:99]
  s_waitcnt lgkmcnt(5)
  v_mfma_f32_16x16x32_bf16 v[64:67], v[152:155], v[120:123], v[64:67]
  s_barrier
  ds_read_b64_tr_b16 v[140:141], v32 offset:18432
  v_mfma_f32_16x16x32_bf16 v[76:79], v[152:155], v[124:127], v[76:79]
  ds_read_b64_tr_b16 v[142:143], v32 offset:19200
  s_waitcnt lgkmcnt(6)
  v_mfma_f32_16x16x32_bf16 v[88:91], v[152:155], v[128:131], v[88:91]
  ds_read_b128 v[132:135], v16 offset:512
  s_waitcnt lgkmcnt(5)
  v_mfma_f32_16x16x32_bf16 v[68:71], v[156:159], v[120:123], v[68:71]
  ds_read_b64_tr_b16 v[144:145], v32 offset:18440
  v_mfma_f32_16x16x32_bf16 v[80:83], v[156:159], v[124:127], v[80:83]
  ds_read_b64_tr_b16 v[146:147], v32 offset:19208
  v_mfma_f32_16x16x32_bf16 v[92:95], v[156:159], v[128:131], v[92:95]
  ds_read_b64_tr_b16 v[148:149], v32 offset:18448
  s_waitcnt lgkmcnt(6)
  v_mfma_f32_16x16x32_bf16 v[72:75], v[160:163], v[120:123], v[72:75]
  ds_read_b64_tr_b16 v[150:151], v32 offset:19216
  v_mfma_f32_16x16x32_bf16 v[84:87], v[160:163], v[124:127], v[84:87]
  v_mfma_f32_16x16x32_bf16 v[96:99], v[160:163], v[128:131], v[96:99]
  s_waitcnt lgkmcnt(5)
  v_mfma_f32_16x16x32_bf16 v[64:67], v[140:143], v[124:127], v[64:67]
  ds_read_b64_tr_b16 v[152:153], v32 offset:21504
  v_mfma_f32_16x16x32_bf16 v[76:79], v[140:143], v[128:131], v[76:79]
  ds_read_b64_tr_b16 v[154:155], v32 offset:22272
  s_waitcnt lgkmcnt(6)
  v_mfma_f32_16x16x32_bf16 v[88:91], v[140:143], v[132:135], v[88:91]
L_hop0:
  s_cbranch_execz L_wr
  ds_read_b128 v[136:139], v17 offset:512
  s_waitcnt lgkmcnt(5)
  v_mfma_f32_16x16x32_bf16 v[68:71], v[144:147], v[124:127], v[68:71]
  ds_read_b128 v[100:103], v24 offset:0
  v_mfma_f32_16x16x32_bf16 v[80:83], v[144:147], v[128:131], v[80:83]
  ds_read_b64_tr_b16 v[156:157], v32 offset:21512
  v_mfma_f32_16x16x32_bf16 v[92:95], v[144:147], v[132:135], v[92:95]
  ds_read_b64_tr_b16 v[158:159], v32 offset:22280
  s_waitcnt lgkmcnt(6)
  v_mfma_f32_16x16x32_bf16 v[72:75], v[148:151], v[124:127], v[72:75]
  ds_read_b64_tr_b16 v[160:161], v32 offset:21520
  v_mfma_f32_16x16x32_bf16 v[84:87], v[148:151], v[128:131], v[84:87]
  ds_read_b64_tr_b16 v[162:163], v32 offset:22288
  v_mfma_f32_16x16x32_bf16 v[96:99], v[148:151], v[132:135], v[96:99]
  s_waitcnt lgkmcnt(6)
  v_mfma_f32_16x16x32_bf16 v[64:67], v[152:155], v[128:131], v[64:67]
  ds_read_b64_tr_b16 v[140:141], v32 offset:24576
  v_mfma_f32_16x16x32_bf16 v[76:79], v[152:155], v[132:135], v[76:79]
  ds_read_b64_tr_b16 v[142:143], v32 offset:25344
  s_waitcnt lgkmcnt(7)
  v_mfma_f32_16x16x32_bf16 v[88:91], v[152:155], v[136:139], v[88:91]
  ds_read_b128 v[104:107], v25 offset:0
  s_waitcnt lgkmcnt(5)
  v_mfma_f32_16x16x32_bf16 v[68:71], v[156:159], v[128:131], v[68:71]
  ds_read_b128 v[108:111], v26 offset:0
  v_mfma_f32_16x16x32_bf16 v[80:83], v[156:159], v[132:135], v[80:83]
  ds_read_b64_tr_b16 v[144:145], v32 offset:24584
  v_mfma_f32_16x16x32_bf16 v[92:95], v[156:159], v[136:139], v[92:95]
  ds_read_b64_tr_b16 v[146:147], v32 offset:25352
  s_waitcnt lgkmcnt(6)
  v_mfma_f32_16x16x32_bf16 v[72:75], v[160:163], v[128:131], v[72:75]
  ds_read_b64_tr_b16 v[148:149], v32 offset:24592
  v_mfma_f32_16x16x32_bf16 v[84:87], v[160:163], v[132:135], v[84:87]
  ds_read_b64_tr_b16 v[150:151], v32 offset:25360
  v_mfma_f32_16x16x32_bf16 v[96:99], v[160:163], v[136:139], v[96:99]
  s_waitcnt lgkmcnt(6)
  v_mfma_f32_16x16x32_bf16 v[64:67], v[140:143], v[100:103], v[64:67]
  s_barrier
  ds_read_b64_tr_b16 v[152:153], v32 offset:27648
  s_waitcnt lgkmcnt(6)
  v_mfma_f32_16x16x32_bf16 v[76:79], v[140:143], v[104:107], v[76:79]
  ds_read_b64_tr_b16 v[154:155], v32 offset:28416
  s_waitcnt lgkmcnt(6)
  v_mfma_f32_16x16x32_bf16 v[88:91], v[140:143], v[108:111], v[88:91]
  ds_read_b128 v[112:115], v27 offset:0
  s_waitcnt lgkmcnt(5)
  v_mfma_f32_16x16x32_bf16 v[68:71], v[144:147], v[100:103], v[68:71]
  ds_read_b64_tr_b16 v[156:157], v32 offset:27656
  v_mfma_f32_16x16x32_bf16 v[80:83], v[144:147], v[104:107], v[80:83]
  ds_read_b64_tr_b16 v[158:159], v32 offset:28424
  v_mfma_f32_16x16x32_bf16 v[92:95], v[144:147], v[108:111], v[92:95]
  ds_read_b64_tr_b16 v[160:161], v32 offset:27664
  s_waitcnt lgkmcnt(6)
  v_mfma_f32_16x16x32_bf16 v[72:75], v[148:151], v[100:103], v[72:75]
  ds_read_b64_tr_b16 v[162:163], v32 offset:28432
  v_mfma_f32_16x16x32_bf16 v[84:87], v[148:151], v[104:107], v[84:87]
  v_mfma_f32_16x16x32_bf16 v[96:99], v[148:151], v[108:111], v[96:99]
  s_waitcnt lgkmcnt(5)
  v_mfma_f32_16x16x32_bf16 v[64:67], v[152:155], v[104:107], v[64:67]
  ds_read_b64_tr_b16 v[140:141], v32 offset:30720
  v_mfma_f32_16x16x32_bf16 v[76:79], v[152:155], v[108:111], v[76:79]
  ds_read_b64_tr_b16 v[142:143], v32 offset:31488
  s_waitcnt lgkmcnt(6)
  v_mfma_f32_16x16x32_bf16 v[88:91], v[152:155], v[112:115], v[88:91]
  ds_read_b128 v[116:119], v28 offset:0
  s_waitcnt lgkmcnt(5)
  v_mfma_f32_16x16x32_bf16 v[68:71], v[156:159], v[104:107], v[68:71]
  ds_read_b64_tr_b16 v[144:145], v32 offset:30728
  v_mfma_f32_16x16x32_bf16 v[80:83], v[156:159], v[108:111], v[80:83]
  ds_read_b64_tr_b16 v[146:147], v32 offset:31496
  v_mfma_f32_16x16x32_bf16 v[92:95], v[156:159], v[112:115], v[92:95]
  ds_read_b64_tr_b16 v[148:149], v32 offset:30736
  s_waitcnt lgkmcnt(6)
  v_mfma_f32_16x16x32_bf16 v[72:75], v[160:163], v[104:107], v[72:75]
  ds_read_b64_tr_b16 v[150:151], v32 offset:31504
  v_mfma_f32_16x16x32_bf16 v[84:87], v[160:163], v[108:111], v[84:87]
  v_mfma_f32_16x16x32_bf16 v[96:99], v[160:163], v[112:115], v[96:99]
  s_waitcnt lgkmcnt(5)
  v_mfma_f32_16x16x32_bf16 v[64:67], v[140:143], v[108:111], v[64:67]
  ds_read_b64_tr_b16 v[152:153], v32 offset:33792
  v_mfma_f32_16x16x32_bf16 v[76:79], v[140:143], v[112:115], v[76:79]
  ds_read_b64_tr_b16 v[154:155], v32 offset:34560
  s_waitcnt lgkmcnt(6)
  v_mfma_f32_16x16x32_bf16 v[88:91], v[140:143], v[116:119], v[88:91]
  ds_read_b128 v[120:123], v29 offset:0
  s_waitcnt lgkmcnt(5)
  v_mfma_f32_16x16x32_bf16 v[68:71], v[144:147], v[108:111], v[68:71]
  ds_read_b64_tr_b16 v[156:157], v32 offset:33800
  v_mfma_f32_16x16x32_bf16 v[80:83], v[144:147], v[112:115], v[80:83]
  ds_read_b64_tr_b16 v[158:159], v32 offset:34568
  v_mfma_f32_16x16x32_bf16 v[92:95], v[144:147], v[116:119], v[92:95]
  ds_read_b64_tr_b16 v[160:161], v32 offset:33808
  s_waitcnt lgkmcnt(6)
  v_mfma_f32_16x16x32_bf16 v[72:75], v[148:151], v[108:111], v[72:75]
  ds_read_b64_tr_b16 v[162:163], v32 offset:34576
  v_mfma_f32_16x16x32_bf16 v[84:87], v[148:151], v[112:115], v[84:87]
  v_mfma_f32_16x16x32_bf16 v[96:99], v[148:151], v[116:119], v[96:99]
  s_waitcnt lgkmcnt(5)
  v_mfma_f32_16x16x32_bf16 v[64:67], v[152:155], v[112:115], v[64:67]
  s_barrier
  ds_read_b64_tr_b16 v[140:141], v32 offset:36864
  v_mfma_f32_16x16x32_bf16 v[76:79], v[152:155], v[116:119], v[76:79]
  ds_read_b64_tr_b16 v[142:143], v32 offset:37632
  s_waitcnt lgkmcnt(6)
  v_mfma_f32_16x16x32_bf16 v[88:91], v[152:155], v[120:123], v[88:91]
  ds_read_b128 v[124:127], v30 offset:0
  s_waitcnt lgkmcnt(5)
  v_mfma_f32_16x16x32_bf16 v[68:71], v[156:159], v[112:115], v[68:71]
  ds_read_b64_tr_b16 v[144:145], v32 offset:36872
  v_mfma_f32_16x16x32_bf16 v[80:83], v[156:159], v[116:119], v[80:83]
  ds_read_b64_tr_b16 v[146:147], v32 offset:37640
  v_mfma_f32_16x16x32_bf16 v[92:95], v[156:159], v[120:123], v[92:95]
  ds_read_b64_tr_b16 v[148:149], v32 offset:36880
  s_waitcnt lgkmcnt(6)
  v_mfma_f32_16x16x32_bf16 v[72:75], v[160:163], v[112:115], v[72:75]
  ds_read_b64_tr_b16 v[150:151], v32 offset:37648
  v_mfma_f32_16x16x32_bf16 v[84:87], v[160:163], v[116:119], v[84:87]
  v_mfma_f32_16x16x32_bf16 v[96:99], v[160:163], v[120:123], v[96:99]
  s_waitcnt lgkmcnt(5)
  v_mfma_f32_16x16x32_bf16 v[64:67], v[140:143], v[116:119], v[64:67]
  ds_read_b64_tr_b16 v[152:153], v32 offset:39936
  v_mfma_f32_16x16x32_bf16 v[76:79], v[140:143], v[120:123], v[76:79]
  ds_read_b64_tr_b16 v[154:155], v32 offset:40704
  s_waitcnt lgkmcnt(6)
  v_mfma_f32_16x16x32_bf16 v[88:91], v[140:143], v[124:127], v[88:91]
  ds_read_b128 v[128:131], v31 offset:0
  s_waitcnt lgkmcnt(5)
  v_mfma_f32_16x16x32_bf16 v[68:71], v[144:147], v[116:119], v[68:71]
  ds_read_b64_tr_b16 v[156:157], v32 offset:39944
  v_mfma_f32_16x16x32_bf16 v[80:83], v[144:147], v[120:123], v[80:83]
  ds_read_b64_tr_b16 v[158:159], v32 offset:40712
  v_mfma_f32_16x16x32_bf16 v[92:95], v[144:147], v[124:127], v[92:95]
  ds_read_b64_tr_b16 v[160:161], v32 offset:39952
  s_waitcnt lgkmcnt(6)
  v_mfma_f32_16x16x32_bf16 v[72:75], v[148:151], v[116:119], v[72:75]
  ds_read_b64_tr_b16 v[162:163], v32 offset:40720
  v_mfma_f32_16x16x32_bf16 v[84:87], v[148:151], v[120:123], v[84:87]
  v_mfma_f32_16x16x32_bf16 v[96:99], v[148:151], v[124:127], v[96:99]
  s_waitcnt lgkmcnt(5)
  v_mfma_f32_16x16x32_bf16 v[64:67], v[152:155], v[120:123], v[64:67]
  ds_read_b64_tr_b16 v[140:141], v32 offset:43008
  v_mfma_f32_16x16x32_bf16 v[76:79], v[152:155], v[124:127], v[76:79]
  ds_read_b64_tr_b16 v[142:143], v32 offset:43776
  s_waitcnt lgkmcnt(6)
  v_mfma_f32_16x16x32_bf16 v[88:91], v[152:155], v[128:131], v[88:91]
  ds_read_b128 v[132:135], v24 offset:512
  s_waitcnt lgkmcnt(5)
  v_mfma_f32_16x16x32_bf16 v[68:71], v[156:159], v[120:123], v[68:71]
  ds_read_b64_tr_b16 v[144:145], v32 offset:43016
  v_mfma_f32_16x16x32_bf16 v[80:83], v[156:159], v[124:127], v[80:83]
  ds_read_b64_tr_b16 v[146:147], v32 offset:43784
  v_mfma_f32_16x16x32_bf16 v[92:95], v[156:159], v[128:131], v[92:95]
  ds_read_b64_tr_b16 v[148:149], v32 offset:43024
  s_waitcnt lgkmcnt(6)
  v_mfma_f32_16x16x32_bf16 v[72:75], v[160:163], v[120:123], v[72:75]
  ds_read_b64_tr_b16 v[150:151], v32 offset:43792
  v_mfma_f32_16x16x32_bf16 v[84:87], v[160:163], v[124:127], v[84:87]
  v_mfma_f32_16x16x32_bf16 v[96:99], v[160:163], v[128:131], v[96:99]
  s_waitcnt lgkmcnt(5)
  v_mfma_f32_16x16x32_bf16 v[64:67], v[140:143], v[124:127], v[64:67]
  s_barrier
  ds_read_b64_tr_b16 v[152:153], v32 offset:0
  v_mfma_f32_16x16x32_bf16 v[76:79], v[140:143], v[128:131], v[76:79]
  ds_read_b64_tr_b16 v[154:155], v32 offset:768
  s_waitcnt lgkmcnt(6)
  v_mfma_f32_16x16x32_bf16 v[88:91], v[140:143], v[132:135], v[88:91]
  ds_read_b128 v[136:139], v25 offset:512
  s_waitcnt lgkmcnt(5)
  v_mfma_f32_16x16x32_bf16 v[68:71], v[144:147], v[124:127], v[68:71]
  ds_read_b128 v[100:103], v16 offset:12800
  v_mfma_f32_16x16x32_bf16 v[80:83], v[144:147], v[128:131], v[80:83]
  ds_read_b64_tr_b16 v[156:157], v32 offset:8
  v_mfma_f32_16x16x32_bf16 v[92:95], v[144:147], v[132:135], v[92:95]
  ds_read_b64_tr_b16 v[158:159], v32 offset:776
  s_waitcnt lgkmcnt(6)
  v_mfma_f32_16x16x32_bf16 v[72:75], v[148:151], v[124:127], v[72:75]
  ds_read_b64_tr_b16 v[160:161], v32 offset:16
  v_mfma_f32_16x16x32_bf16 v[84:87], v[148:151], v[128:131], v[84:87]
  ds_read_b64_tr_b16 v[162:163], v32 offset:784
  v_mfma_f32_16x16x32_bf16 v[96:99], v[148:151], v[132:135], v[96:99]
  s_waitcnt lgkmcnt(6)
  v_mfma_f32_16x16x32_bf16 v[64:67], v[152:155], v[128:131], v[64:67]
  ds_read_b64_tr_b16 v[140:141], v32 offset:3072
  v_mfma_f32_16x16x32_bf16 v[76:79], v[152:155], v[132:135], v[76:79]
  ds_read_b64_tr_b16 v[142:143], v32 offset:3840
  s_waitcnt lgkmcnt(7)
  v_mfma_f32_16x16x32_bf16 v[88:91], v[152:155], v[136:139], v[88:91]
  ds_read_b128 v[104:107], v17 offset:12800
  s_waitcnt lgkmcnt(5)
  v_mfma_f32_16x16x32_bf16 v[68:71], v[156:159], v[128:131], v[68:71]
  ds_read_b128 v[108:111], v18 offset:12800
  v_mfma_f32_16x16x32_bf16 v[80:83], v[156:159], v[132:135], v[80:83]
  ds_read_b64_tr_b16 v[144:145], v32 offset:3080
  v_mfma_f32_16x16x32_bf16 v[92:95], v[156:159], v[136:139], v[92:95]
  ds_read_b64_tr_b16 v[146:147], v32 offset:3848
  s_waitcnt lgkmcnt(6)
  v_mfma_f32_16x16x32_bf16 v[72:75], v[160:163], v[128:131], v[72:75]
  ds_read_b64_tr_b16 v[148:149], v32 offset:3088
  v_mfma_f32_16x16x32_bf16 v[84:87], v[160:163], v[132:135], v[84:87]
  ds_read_b64_tr_b16 v[150:151], v32 offset:3856
  v_mfma_f32_16x16x32_bf16 v[96:99], v[160:163], v[136:139], v[96:99]
  s_waitcnt lgkmcnt(6)
  v_mfma_f32_16x16x32_bf16 v[64:67], v[140:143], v[100:103], v[64:67]
  ds_read_b64_tr_b16 v[152:153], v32 offset:6144
  s_waitcnt lgkmcnt(6)
  v_mfma_f32_16x16x32_bf16 v[76:79], v[140:143], v[104:107], v[76:79]
  ds_read_b64_tr_b16 v[154:155], v32 offset:6912
  s_waitcnt lgkmcnt(6)
  v_mfma_f32_16x16x32_bf16 v[88:91], v[140:143], v[108:111], v[88:91]
  ds_read_b128 v[112:115], v19 offset:12800
  s_waitcnt lgkmcnt(5)
  v_mfma_f32_16x16x32_bf16 v[68:71], v[144:147], v[100:103], v[68:71]
  ds_read_b64_tr_b16 v[156:157], v32 offset:6152
  v_mfma_f32_16x16x32_bf16 v[80:83], v[144:147], v[104:107], v[80:83]
  ds_read_b64_tr_b16 v[158:159], v32 offset:6920
  v_mfma_f32_16x16x32_bf16 v[92:95], v[144:147], v[108:111], v[92:95]
  ds_read_b64_tr_b16 v[160:161], v32 offset:6160
  s_waitcnt lgkmcnt(6)
  v_mfma_f32_16x16x32_bf16 v[72:75], v[148:151], v[100:103], v[72:75]
  ds_read_b64_tr_b16 v[162:163], v32 offset:6928
  v_mfma_f32_16x16x32_bf16 v[84:87], v[148:151], v[104:107], v[84:87]
  v_mfma_f32_16x16x32_bf16 v[96:99], v[148:151], v[108:111], v[96:99]
  s_waitcnt lgkmcnt(5)
  v_mfma_f32_16x16x32_bf16 v[64:67], v[152:155], v[104:107], v[64:67]
  s_barrier
  ds_read_b64_tr_b16 v[140:141], v32 offset:9216
  v_mfma_f32_16x16x32_bf16 v[76:79], v[152:155], v[108:111], v[76:79]
  ds_read_b64_tr_b16 v[142:143], v32 offset:9984
  s_waitcnt lgkmcnt(6)
  v_mfma_f32_16x16x32_bf16 v[88:91], v[152:155], v[112:115], v[88:91]
  ds_read_b128 v[116:119], v20 offset:12800
  s_waitcnt lgkmcnt(5)
  v_mfma_f32_16x16x32_bf16 v[68:71], v[156:159], v[104:107], v[68:71]
  ds_read_b64_tr_b16 v[144:145], v32 offset:9224
  v_mfma_f32_16x16x32_bf16 v[80:83], v[156:159], v[108:111], v[80:83]
  ds_read_b64_tr_b16 v[146:147], v32 offset:9992
  v_mfma_f32_16x16x32_bf16 v[92:95], v[156:159], v[112:115], v[92:95]
  ds_read_b64_tr_b16 v[148:149], v32 offset:9232
  s_waitcnt lgkmcnt(6)
  v_mfma_f32_16x16x32_bf16 v[72:75], v[160:163], v[104:107], v[72:75]
  ds_read_b64_tr_b16 v[150:151], v32 offset:10000
  v_mfma_f32_16x16x32_bf16 v[84:87], v[160:163], v[108:111], v[84:87]
  v_mfma_f32_16x16x32_bf16 v[96:99], v[160:163], v[112:115], v[96:99]
  s_waitcnt lgkmcnt(5)
  v_mfma_f32_16x16x32_bf16 v[64:67], v[140:143], v[108:111], v[64:67]
  ds_read_b64_tr_b16 v[152:153], v32 offset:12288
  v_mfma_f32_16x16x32_bf16 v[76:79], v[140:143], v[112:115], v[76:79]
  ds_read_b64_tr_b16 v[154:155], v32 offset:13056
  s_waitcnt lgkmcnt(6)
  v_mfma_f32_16x16x32_bf16 v[88:91], v[140:143], v[116:119], v[88:91]
  ds_read_b128 v[120:123], v21 offset:12800
  s_waitcnt lgkmcnt(5)
  v_mfma_f32_16x16x32_bf16 v[68:71], v[144:147], v[108:111], v[68:71]
  ds_read_b64_tr_b16 v[156:157], v32 offset:12296
  v_mfma_f32_16x16x32_bf16 v[80:83], v[144:147], v[112:115], v[80:83]
  ds_read_b64_tr_b16 v[158:159], v32 offset:13064
  v_mfma_f32_16x16x32_bf16 v[92:95], v[144:147], v[116:119], v[92:95]
  ds_read_b64_tr_b16 v[160:161], v32 offset:12304
  s_waitcnt lgkmcnt(6)
  v_mfma_f32_16x16x32_bf16 v[72:75], v[148:151], v[108:111], v[72:75]
  ds_read_b64_tr_b16 v[162:163], v32 offset:13072
  v_mfma_f32_16x16x32_bf16 v[84:87], v[148:151], v[112:115], v[84:87]
  v_mfma_f32_16x16x32_bf16 v[96:99], v[148:151], v[116:119], v[96:99]
  s_waitcnt lgkmcnt(5)
  v_mfma_f32_16x16x32_bf16 v[64:67], v[152:155], v[112:115], v[64:67]
  ds_read_b64_tr_b16 v[140:141], v32 offset:15360
  v_mfma_f32_16x16x32_bf16 v[76:79], v[152:155], v[116:119], v[76:79]
  ds_read_b64_tr_b16 v[142:143], v32 offset:16128
  s_waitcnt lgkmcnt(6)
  v_mfma_f32_16x16x32_bf16 v[88:91], v[152:155], v[120:123], v[88:91]
  ds_read_b128 v[124:127], v22 offset:12800
  s_waitcnt lgkmcnt(5)
  v_mfma_f32_16x16x32_bf16 v[68:71], v[156:159], v[112:115], v[68:71]
  ds_read_b64_tr_b16 v[144:145], v32 offset:15368
  v_mfma_f32_16x16x32_bf16 v[80:83], v[156:159], v[116:119], v[80:83]
  ds_read_b64_tr_b16 v[146:147], v32 offset:16136
  v_mfma_f32_16x16x32_bf16 v[92:95], v[156:159], v[120:123], v[92:95]
  ds_read_b64_tr_b16 v[148:149], v32 offset:15376
  s_waitcnt lgkmcnt(6)
  v_mfma_f32_16x16x32_bf16 v[72:75], v[160:163], v[112:115], v[72:75]
  ds_read_b64_tr_b16 v[150:151], v32 offset:16144
  v_mfma_f32_16x16x32_bf16 v[84:87], v[160:163], v[116:119], v[84:87]
  v_mfma_f32_16x16x32_bf16 v[96:99], v[160:163], v[120:123], v[96:99]
  s_waitcnt lgkmcnt(5)
  v_mfma_f32_16x16x32_bf16 v[64:67], v[140:143], v[116:119], v[64:67]
  s_barrier
  ds_read_b64_tr_b16 v[152:153], v32 offset:18432
  v_mfma_f32_16x16x32_bf16 v[76:79], v[140:143], v[120:123], v[76:79]
  ds_read_b64_tr_b16 v[154:155], v32 offset:19200
  s_waitcnt lgkmcnt(6)
  v_mfma_f32_16x16x32_bf16 v[88:91], v[140:143], v[124:127], v[88:91]
  ds_read_b128 v[128:131], v23 offset:12800
  s_waitcnt lgkmcnt(5)
  v_mfma_f32_16x16x32_bf16 v[68:71], v[144:147], v[116:119], v[68:71]
  ds_read_b64_tr_b16 v[156:157], v32 offset:18440
  v_mfma_f32_16x16x32_bf16 v[80:83], v[144:147], v[120:123], v[80:83]
  ds_read_b64_tr_b16 v[158:159], v32 offset:19208
  v_mfma_f32_16x16x32_bf16 v[92:95], v[144:147], v[124:127], v[92:95]
  ds_read_b64_tr_b16 v[160:161], v32 offset:18448
  s_waitcnt lgkmcnt(6)
  v_mfma_f32_16x16x32_bf16 v[72:75], v[148:151], v[116:119], v[72:75]
  ds_read_b64_tr_b16 v[162:163], v32 offset:19216
  v_mfma_f32_16x16x32_bf16 v[84:87], v[148:151], v[120:123], v[84:87]
  v_mfma_f32_16x16x32_bf16 v[96:99], v[148:151], v[124:127], v[96:99]
  s_waitcnt lgkmcnt(5)
  v_mfma_f32_16x16x32_bf16 v[64:67], v[152:155], v[120:123], v[64:67]
  ds_read_b64_tr_b16 v[140:141], v32 offset:21504
  v_mfma_f32_16x16x32_bf16 v[76:79], v[152:155], v[124:127], v[76:79]
  ds_read_b64_tr_b16 v[142:143], v32 offset:22272
  s_waitcnt lgkmcnt(6)
  v_mfma_f32_16x16x32_bf16 v[88:91], v[152:155], v[128:131], v[88:91]
  ds_read_b128 v[132:135], v16 offset:13312
  s_waitcnt lgkmcnt(5)
  v_mfma_f32_16x16x32_bf16 v[68:71], v[156:159], v[120:123], v[68:71]
  ds_read_b64_tr_b16 v[144:145], v32 offset:21512
  v_mfma_f32_16x16x32_bf16 v[80:83], v[156:159], v[124:127], v[80:83]
  ds_read_b64_tr_b16 v[146:147], v32 offset:22280
  v_mfma_f32_16x16x32_bf16 v[92:95], v[156:159], v[128:131], v[92:95]
  ds_read_b64_tr_b16 v[148:149], v32 offset:21520
  s_waitcnt lgkmcnt(6)
  v_mfma_f32_16x16x32_bf16 v[72:75], v[160:163], v[120:123], v[72:75]
  ds_read_b64_tr_b16 v[150:151], v32 offset:22288
  v_mfma_f32_16x16x32_bf16 v[84:87], v[160:163], v[124:127], v[84:87]
  v_mfma_f32_16x16x32_bf16 v[96:99], v[160:163], v[128:131], v[96:99]
  s_waitcnt lgkmcnt(5)
  v_mfma_f32_16x16x32_bf16 v[64:67], v[140:143], v[124:127], v[64:67]
  ds_read_b64_tr_b16 v[152:153], v32 offset:24576
  v_mfma_f32_16x16x32_bf16 v[76:79], v[140:143], v[128:131], v[76:79]
  ds_read_b64_tr_b16 v[154:155], v32 offset:25344
  s_waitcnt lgkmcnt(6)
  v_mfma_f32_16x16x32_bf16 v[88:91], v[140:143], v[132:135], v[88:91]
  ds_read_b128 v[136:139], v17 offset:13312
  s_waitcnt lgkmcnt(5)
  v_mfma_f32_16x16x32_bf16 v[68:71], v[144:147], v[124:127], v[68:71]
  ds_read_b128 v[100:103], v24 offset:12800
  v_mfma_f32_16x16x32_bf16 v[80:83], v[144:147], v[128:131], v[80:83]
  ds_read_b64_tr_b16 v[156:157], v32 offset:24584
  v_mfma_f32_16x16x32_bf16 v[92:95], v[144:147], v[132:135], v[92:95]
  ds_read_b64_tr_b16 v[158:159], v32 offset:25352
  s_waitcnt lgkmcnt(6)
  v_mfma_f32_16x16x32_bf16 v[72:75], v[148:151], v[124:127], v[72:75]
  ds_read_b64_tr_b16 v[160:161], v32 offset:24592
  v_mfma_f32_16x16x32_bf16 v[84:87], v[148:151], v[128:131], v[84:87]
  ds_read_b64_tr_b16 v[162:163], v32 offset:25360
  v_mfma_f32_16x16x32_bf16 v[96:99], v[148:151], v[132:135], v[96:99]
  s_waitcnt lgkmcnt(6)
  v_mfma_f32_16x16x32_bf16 v[64:67], v[152:155], v[128:131], v[64:67]
  s_barrier
  ds_read_b64_tr_b16 v[140:141], v32 offset:27648
  v_mfma_f32_16x16x32_bf16 v[76:79], v[152:155], v[132:135], v[76:79]
  ds_read_b64_tr_b16 v[142:143], v32 offset:28416
  s_waitcnt lgkmcnt(7)
  v_mfma_f32_16x16x32_bf16 v[88:91], v[152:155], v[136:139], v[88:91]
  ds_read_b128 v[104:107], v25 offset:12800
  s_waitcnt lgkmcnt(5)
  v_mfma_f32_16x16x32_bf16 v[68:71], v[156:159], v[128:131], v[68:71]
  ds_read_b128 v[108:111], v26 offset:12800
  v_mfma_f32_16x16x32_bf16 v[80:83], v[156:159], v[132:135], v[80:83]
  ds_read_b64_tr_b16 v[144:145], v32 offset:27656
  v_mfma_f32_16x16x32_bf16 v[92:95], v[156:159], v[136:139], v[92:95]
  ds_read_b64_tr_b16 v[146:147], v32 offset:28424
  s_waitcnt lgkmcnt(6)
  v_mfma_f32_16x16x32_bf16 v[72:75], v[160:163], v[128:131], v[72:75]
  ds_read_b64_tr_b16 v[148:149], v32 offset:27664
  v_mfma_f32_16x16x32_bf16 v[84:87], v[160:163], v[132:135], v[84:87]
  ds_read_b64_tr_b16 v[150:151], v32 offset:28432
  v_mfma_f32_16x16x32_bf16 v[96:99], v[160:163], v[136:139], v[96:99]
  s_waitcnt lgkmcnt(6)
  v_mfma_f32_16x16x32_bf16 v[64:67], v[140:143], v[100:103], v[64:67]
  ds_read_b64_tr_b16 v[152:153], v32 offset:30720
  s_waitcnt lgkmcnt(6)
  v_mfma_f32_16x16x32_bf16 v[76:79], v[140:143], v[104:107], v[76:79]
  ds_read_b64_tr_b16 v[154:155], v32 offset:31488
  s_waitcnt lgkmcnt(6)
  v_mfma_f32_16x16x32_bf16 v[88:91], v[140:143], v[108:111], v[88:91]
  ds_read_b128 v[112:115], v27 offset:12800
  s_waitcnt lgkmcnt(5)
  v_mfma_f32_16x16x32_bf16 v[68:71], v[144:147], v[100:103], v[68:71]
  ds_read_b64_tr_b16 v[156:157], v32 offset:30728
  v_mfma_f32_16x16x32_bf16 v[80:83], v[144:147], v[104:107], v[80:83]
  ds_read_b64_tr_b16 v[158:159], v32 offset:31496
  v_mfma_f32_16x16x32_bf16 v[92:95], v[144:147], v[108:111], v[92:95]
  ds_read_b64_tr_b16 v[160:161], v32 offset:30736
  s_waitcnt lgkmcnt(6)
  v_mfma_f32_16x16x32_bf16 v[72:75], v[148:151], v[100:103], v[72:75]
  ds_read_b64_tr_b16 v[162:163], v32 offset:31504
  v_mfma_f32_16x16x32_bf16 v[84:87], v[148:151], v[104:107], v[84:87]
  v_mfma_f32_16x16x32_bf16 v[96:99], v[148:151], v[108:111], v[96:99]
  s_waitcnt lgkmcnt(5)
  v_mfma_f32_16x16x32_bf16 v[64:67], v[152:155], v[104:107], v[64:67]
  ds_read_b64_tr_b16 v[140:141], v32 offset:33792
  v_mfma_f32_16x16x32_bf16 v[76:79], v[152:155], v[108:111], v[76:79]
  ds_read_b64_tr_b16 v[142:143], v32 offset:34560
  s_waitcnt lgkmcnt(6)
  v_mfma_f32_16x16x32_bf16 v[88:91], v[152:155], v[112:115], v[88:91]
  ds_read_b128 v[116:119], v28 offset:12800
  s_waitcnt lgkmcnt(5)
  v_mfma_f32_16x16x32_bf16 v[68:71], v[156:159], v[104:107], v[68:71]
  ds_read_b64_tr_b16 v[144:145], v32 offset:33800
  v_mfma_f32_16x16x32_bf16 v[80:83], v[156:159], v[108:111], v[80:83]
  ds_read_b64_tr_b16 v[146:147], v32 offset:34568
  v_mfma_f32_16x16x32_bf16 v[92:95], v[156:159], v[112:115], v[92:95]
  ds_read_b64_tr_b16 v[148:149], v32 offset:33808
  s_waitcnt lgkmcnt(6)
  v_mfma_f32_16x16x32_bf16 v[72:75], v[160:163], v[104:107], v[72:75]
  ds_read_b64_tr_b16 v[150:151], v32 offset:34576
  v_mfma_f32_16x16x32_bf16 v[84:87], v[160:163], v[108:111], v[84:87]
  v_mfma_f32_16x16x32_bf16 v[96:99], v[160:163], v[112:115], v[96:99]
  s_waitcnt lgkmcnt(5)
  v_mfma_f32_16x16x32_bf16 v[64:67], v[140:143], v[108:111], v[64:67]
  s_barrier
  ds_read_b64_tr_b16 v[152:153], v32 offset:36864
  v_mfma_f32_16x16x32_bf16 v[76:79], v[140:143], v[112:115], v[76:79]
  ds_read_b64_tr_b16 v[154:155], v32 offset:37632
  s_waitcnt lgkmcnt(6)
  v_mfma_f32_16x16x32_bf16 v[88:91], v[140:143], v[116:119], v[88:91]
  ds_read_b128 v[120:123], v29 offset:12800
  s_waitcnt lgkmcnt(5)
  v_mfma_f32_16x16x32_bf16 v[68:71], v[144:147], v[108:111], v[68:71]
  ds_read_b64_tr_b16 v[156:157], v32 offset:36872
  v_mfma_f32_16x16x32_bf16 v[80:83], v[144:147], v[112:115], v[80:83]
  ds_read_b64_tr_b16 v[158:159], v32 offset:37640
  v_mfma_f32_16x16x32_bf16 v[92:95], v[144:147], v[116:119], v[92:95]
  ds_read_b64_tr_b16 v[160:161], v32 offset:36880
  s_waitcnt lgkmcnt(6)
  v_mfma_f32_16x16x32_bf16 v[72:75], v[148:151], v[108:111], v[72:75]
  ds_read_b64_tr_b16 v[162:163], v32 offset:37648
  v_mfma_f32_16x16x32_bf16 v[84:87], v[148:151], v[112:115], v[84:87]
  v_mfma_f32_16x16x32_bf16 v[96:99], v[148:151], v[116:119], v[96:99]
  s_waitcnt lgkmcnt(5)
  v_mfma_f32_16x16x32_bf16 v[64:67], v[152:155], v[112:115], v[64:67]
  ds_read_b64_tr_b16 v[140:141], v32 offset:39936
  v_mfma_f32_16x16x32_bf16 v[76:79], v[152:155], v[116:119], v[76:79]
  ds_read_b64_tr_b16 v[142:143], v32 offset:40704
  s_waitcnt lgkmcnt(6)
  v_mfma_f32_16x16x32_bf16 v[88:91], v[152:155], v[120:123], v[88:91]
  ds_read_b128 v[124:127], v30 offset:12800
  s_waitcnt lgkmcnt(5)
  v_mfma_f32_16x16x32_bf16 v[68:71], v[156:159], v[112:115], v[68:71]
  ds_read_b64_tr_b16 v[144:145], v32 offset:39944
  v_mfma_f32_16x16x32_bf16 v[80:83], v[156:159], v[116:119], v[80:83]
  ds_read_b64_tr_b16 v[146:147], v32 offset:40712
  v_mfma_f32_16x16x32_bf16 v[92:95], v[156:159], v[120:123], v[92:95]
  ds_read_b64_tr_b16 v[148:149], v32 offset:39952
  s_waitcnt lgkmcnt(6)
  v_mfma_f32_16x16x32_bf16 v[72:75], v[160:163], v[112:115], v[72:75]
  ds_read_b64_tr_b16 v[150:151], v32 offset:40720
  v_mfma_f32_16x16x32_bf16 v[84:87], v[160:163], v[116:119], v[84:87]
  v_mfma_f32_16x16x32_bf16 v[96:99], v[160:163], v[120:123], v[96:99]
  s_waitcnt lgkmcnt(5)
  v_mfma_f32_16x16x32_bf16 v[64:67], v[140:143], v[116:119], v[64:67]
  ds_read_b64_tr_b16 v[152:153], v32 offset:43008
  v_mfma_f32_16x16x32_bf16 v[76:79], v[140:143], v[120:123], v[76:79]
  ds_read_b64_tr_b16 v[154:155], v32 offset:43776
  s_waitcnt lgkmcnt(6)
  v_mfma_f32_16x16x32_bf16 v[88:91], v[140:143], v[124:127], v[88:91]
  ds_read_b128 v[128:131], v31 offset:12800
  s_waitcnt lgkmcnt(5)
  v_mfma_f32_16x16x32_bf16 v[68:71], v[144:147], v[116:119], v[68:71]
  ds_read_b64_tr_b16 v[156:157], v32 offset:43016
  v_mfma_f32_16x16x32_bf16 v[80:83], v[144:147], v[120:123], v[80:83]
  ds_read_b64_tr_b16 v[158:159], v32 offset:43784
  v_mfma_f32_16x16x32_bf16 v[92:95], v[144:147], v[124:127], v[92:95]
  ds_read_b64_tr_b16 v[160:161], v32 offset:43024
  s_waitcnt lgkmcnt(6)
  v_mfma_f32_16x16x32_bf16 v[72:75], v[148:151], v[116:119], v[72:75]
  ds_read_b64_tr_b16 v[162:163], v32 offset:43792
  v_mfma_f32_16x16x32_bf16 v[84:87], v[148:151], v[120:123], v[84:87]
  v_mfma_f32_16x16x32_bf16 v[96:99], v[148:151], v[124:127], v[96:99]
  s_waitcnt lgkmcnt(5)
  v_mfma_f32_16x16x32_bf16 v[64:67], v[152:155], v[120:123], v[64:67]
  s_barrier
  ds_read_b64_tr_b16 v[140:141], v32 offset:0
  v_mfma_f32_16x16x32_bf16 v[76:79], v[152:155], v[124:127], v[76:79]
  ds_read_b64_tr_b16 v[142:143], v32 offset:768
  s_waitcnt lgkmcnt(6)
  v_mfma_f32_16x16x32_bf16 v[88:91], v[152:155], v[128:131], v[88:91]
  ds_read_b128 v[132:135], v24 offset:13312
  s_waitcnt lgkmcnt(5)
  v_mfma_f32_16x16x32_bf16 v[68:71], v[156:159], v[120:123], v[68:71]
  ds_read_b64_tr_b16 v[144:145], v32 offset:8
  v_mfma_f32_16x16x32_bf16 v[80:83], v[156:159], v[124:127], v[80:83]
  ds_read_b64_tr_b16 v[146:147], v32 offset:776
  v_mfma_f32_16x16x32_bf16 v[92:95], v[156:159], v[128:131], v[92:95]
  ds_read_b64_tr_b16 v[148:149], v32 offset:16
  s_waitcnt lgkmcnt(6)
  v_mfma_f32_16x16x32_bf16 v[72:75], v[160:163], v[120:123], v[72:75]
  ds_read_b64_tr_b16 v[150:151], v32 offset:784
  v_mfma_f32_16x16x32_bf16 v[84:87], v[160:163], v[124:127], v[84:87]
  v_mfma_f32_16x16x32_bf16 v[96:99], v[160:163], v[128:131], v[96:99]
  s_waitcnt lgkmcnt(5)
  v_mfma_f32_16x16x32_bf16 v[64:67], v[140:143], v[124:127], v[64:67]
  ds_read_b64_tr_b16 v[152:153], v32 offset:3072
  v_mfma_f32_16x16x32_bf16 v[76:79], v[140:143], v[128:131], v[76:79]
  ds_read_b64_tr_b16 v[154:155], v32 offset:3840
  s_waitcnt lgkmcnt(6)
  v_mfma_f32_16x16x32_bf16 v[88:91], v[140:143], v[132:135], v[88:91]
  ds_read_b128 v[136:139], v25 offset:13312
  s_waitcnt lgkmcnt(5)
  v_mfma_f32_16x16x32_bf16 v[68:71], v[144:147], v[124:127], v[68:71]
  ds_read_b128 v[100:103], v16 offset:25600
  v_mfma_f32_16x16x32_bf16 v[80:83], v[144:147], v[128:131], v[80:83]
  ds_read_b64_tr_b16 v[156:157], v32 offset:3080
  v_mfma_f32_16x16x32_bf16 v[92:95], v[144:147], v[132:135], v[92:95]
  ds_read_b64_tr_b16 v[158:159], v32 offset:3848
  s_waitcnt lgkmcnt(6)
  v_mfma_f32_16x16x32_bf16 v[72:75], v[148:151], v[124:127], v[72:75]
  ds_read_b64_tr_b16 v[160:161], v32 offset:3088
  v_mfma_f32_16x16x32_bf16 v[84:87], v[148:151], v[128:131], v[84:87]
  ds_read_b64_tr_b16 v[162:163], v32 offset:3856
  v_mfma_f32_16x16x32_bf16 v[96:99], v[148:151], v[132:135], v[96:99]
  s_waitcnt lgkmcnt(6)
  v_mfma_f32_16x16x32_bf16 v[64:67], v[152:155], v[128:131], v[64:67]
  ds_read_b64_tr_b16 v[140:141], v32 offset:6144
  v_mfma_f32_16x16x32_bf16 v[76:79], v[152:155], v[132:135], v[76:79]
  ds_read_b64_tr_b16 v[142:143], v32 offset:6912
  s_waitcnt lgkmcnt(7)
  v_mfma_f32_16x16x32_bf16 v[88:91], v[152:155], v[136:139], v[88:91]
  ds_read_b128 v[104:107], v17 offset:25600
  s_waitcnt lgkmcnt(5)
  v_mfma_f32_16x16x32_bf16 v[68:71], v[156:159], v[128:131], v[68:71]
  ds_read_b128 v[108:111], v18 offset:25600
  v_mfma_f32_16x16x32_bf16 v[80:83], v[156:159], v[132:135], v[80:83]
  ds_read_b64_tr_b16 v[144:145], v32 offset:6152
  v_mfma_f32_16x16x32_bf16 v[92:95], v[156:159], v[136:139], v[92:95]
  ds_read_b64_tr_b16 v[146:147], v32 offset:6920
  s_waitcnt lgkmcnt(6)
  v_mfma_f32_16x16x32_bf16 v[72:75], v[160:163], v[128:131], v[72:75]
  ds_read_b64_tr_b16 v[148:149], v32 offset:6160
  v_mfma_f32_16x16x32_bf16 v[84:87], v[160:163], v[132:135], v[84:87]
  ds_read_b64_tr_b16 v[150:151], v32 offset:6928
  v_mfma_f32_16x16x32_bf16 v[96:99], v[160:163], v[136:139], v[96:99]
  s_waitcnt lgkmcnt(6)
  v_mfma_f32_16x16x32_bf16 v[64:67], v[140:143], v[100:103], v[64:67]
  s_barrier
  ds_read_b64_tr_b16 v[152:153], v32 offset:9216
  s_waitcnt lgkmcnt(6)
  v_mfma_f32_16x16x32_bf16 v[76:79], v[140:143], v[104:107], v[76:79]
  ds_read_b64_tr_b16 v[154:155], v32 offset:9984
  s_waitcnt lgkmcnt(6)
  v_mfma_f32_16x16x32_bf16 v[88:91], v[140:143], v[108:111], v[88:91]
  ds_read_b128 v[112:115], v19 offset:25600
  s_waitcnt lgkmcnt(5)
  v_mfma_f32_16x16x32_bf16 v[68:71], v[144:147], v[100:103], v[68:71]
  ds_read_b64_tr_b16 v[156:157], v32 offset:9224
  v_mfma_f32_16x16x32_bf16 v[80:83], v[144:147], v[104:107], v[80:83]
  ds_read_b64_tr_b16 v[158:159], v32 offset:9992
  v_mfma_f32_16x16x32_bf16 v[92:95], v[144:147], v[108:111], v[92:95]
  ds_read_b64_tr_b16 v[160:161], v32 offset:9232
  s_waitcnt lgkmcnt(6)
  v_mfma_f32_16x16x32_bf16 v[72:75], v[148:151], v[100:103], v[72:75]
  ds_read_b64_tr_b16 v[162:163], v32 offset:10000
  v_mfma_f32_16x16x32_bf16 v[84:87], v[148:151], v[104:107], v[84:87]
  v_mfma_f32_16x16x32_bf16 v[96:99], v[148:151], v[108:111], v[96:99]
  s_waitcnt lgkmcnt(5)
  v_mfma_f32_16x16x32_bf16 v[64:67], v[152:155], v[104:107], v[64:67]
  ds_read_b64_tr_b16 v[140:141], v32 offset:12288
  v_mfma_f32_16x16x32_bf16 v[76:79], v[152:155], v[108:111], v[76:79]
  ds_read_b64_tr_b16 v[142:143], v32 offset:13056
  s_waitcnt lgkmcnt(6)
  v_mfma_f32_16x16x32_bf16 v[88:91], v[152:155], v[112:115], v[88:91]
  ds_read_b128 v[116:119], v20 offset:25600
  s_waitcnt lgkmcnt(5)
  v_mfma_f32_16x16x32_bf16 v[68:71], v[156:159], v[104:107], v[68:71]
  ds_read_b64_tr_b16 v[144:145], v32 offset:12296
  v_mfma_f32_16x16x32_bf16 v[80:83], v[156:159], v[108:111], v[80:83]
  ds_read_b64_tr_b16 v[146:147], v32 offset:13064
  v_mfma_f32_16x16x32_bf16 v[92:95], v[156:159], v[112:115], v[92:95]
  ds_read_b64_tr_b16 v[148:149], v32 offset:12304
  s_waitcnt lgkmcnt(6)
  v_mfma_f32_16x16x32_bf16 v[72:75], v[160:163], v[104:107], v[72:75]
  ds_read_b64_tr_b16 v[150:151], v32 offset:13072
  v_mfma_f32_16x16x32_bf16 v[84:87], v[160:163], v[108:111], v[84:87]
L_hop1:
  s_cbranch_execz L_wr
  v_mfma_f32_16x16x32_bf16 v[96:99], v[160:163], v[112:115], v[96:99]
  s_waitcnt lgkmcnt(5)
  v_mfma_f32_16x16x32_bf16 v[64:67], v[140:143], v[108:111], v[64:67]
  ds_read_b64_tr_b16 v[152:153], v32 offset:15360
  v_mfma_f32_16x16x32_bf16 v[76:79], v[140:143], v[112:115], v[76:79]
  ds_read_b64_tr_b16 v[154:155], v32 offset:16128
  s_waitcnt lgkmcnt(6)
  v_mfma_f32_16x16x32_bf16 v[88:91], v[140:143], v[116:119], v[88:91]
  ds_read_b128 v[120:123], v21 offset:25600
  s_waitcnt lgkmcnt(5)
  v_mfma_f32_16x16x32_bf16 v[68:71], v[144:147], v[108:111], v[68:71]
  ds_read_b64_tr_b16 v[156:157], v32 offset:15368
  v_mfma_f32_16x16x32_bf16 v[80:83], v[144:147], v[112:115], v[80:83]
  ds_read_b64_tr_b16 v[158:159], v32 offset:16136
  v_mfma_f32_16x16x32_bf16 v[92:95], v[144:147], v[116:119], v[92:95]
  ds_read_b64_tr_b16 v[160:161], v32 offset:15376
  s_waitcnt lgkmcnt(6)
  v_mfma_f32_16x16x32_bf16 v[72:75], v[148:151], v[108:111], v[72:75]
  ds_read_b64_tr_b16 v[162:163], v32 offset:16144
  v_mfma_f32_16x16x32_bf16 v[84:87], v[148:151], v[112:115], v[84:87]
  v_mfma_f32_16x16x32_bf16 v[96:99], v[148:151], v[116:119], v[96:99]
  s_waitcnt lgkmcnt(5)
  v_mfma_f32_16x16x32_bf16 v[64:67], v[152:155], v[112:115], v[64:67]
  s_barrier
  ds_read_b64_tr_b16 v[140:141], v32 offset:18432
  v_mfma_f32_16x16x32_bf16 v[76:79], v[152:155], v[116:119], v[76:79]
  ds_read_b64_tr_b16 v[142:143], v32 offset:19200
  s_waitcnt lgkmcnt(6)
  v_mfma_f32_16x16x32_bf16 v[88:91], v[152:155], v[120:123], v[88:91]
  ds_read_b128 v[124:127], v22 offset:25600
  s_waitcnt lgkmcnt(5)
  v_mfma_f32_16x16x32_bf16 v[68:71], v[156:159], v[112:115], v[68:71]
  ds_read_b64_tr_b16 v[144:145], v32 offset:18440
  v_mfma_f32_16x16x32_bf16 v[80:83], v[156:159], v[116:119], v[80:83]
  ds_read_b64_tr_b16 v[146:147], v32 offset:19208
  v_mfma_f32_16x16x32_bf16 v[92:95], v[156:159], v[120:123], v[92:95]
  ds_read_b64_tr_b16 v[148:149], v32 offset:18448
  s_waitcnt lgkmcnt(6)
  v_mfma_f32_16x16x32_bf16 v[72:75], v[160:163], v[112:115], v[72:75]
  ds_read_b64_tr_b16 v[150:151], v32 offset:19216
  v_mfma_f32_16x16x32_bf16 v[84:87], v[160:163], v[116:119], v[84:87]
  v_mfma_f32_16x16x32_bf16 v[96:99], v[160:163], v[120:123], v[96:99]
  s_waitcnt lgkmcnt(5)
  v_mfma_f32_16x16x32_bf16 v[64:67], v[140:143], v[116:119], v[64:67]
  ds_read_b64_tr_b16 v[152:153], v32 offset:21504
  v_mfma_f32_16x16x32_bf16 v[76:79], v[140:143], v[120:123], v[76:79]
  ds_read_b64_tr_b16 v[154:155], v32 offset:22272
  s_waitcnt lgkmcnt(6)
  v_mfma_f32_16x16x32_bf16 v[88:91], v[140:143], v[124:127], v[88:91]
  ds_read_b128 v[128:131], v23 offset:25600
  s_waitcnt lgkmcnt(5)
  v_mfma_f32_16x16x32_bf16 v[68:71], v[144:147], v[116:119], v[68:71]
  ds_read_b64_tr_b16 v[156:157], v32 offset:21512
  v_mfma_f32_16x16x32_bf16 v[80:83], v[144:147], v[120:123], v[80:83]
  ds_read_b64_tr_b16 v[158:159], v32 offset:22280
  v_mfma_f32_16x16x32_bf16 v[92:95], v[144:147], v[124:127], v[92:95]
  ds_read_b64_tr_b16 v[160:161], v32 offset:21520
  s_waitcnt lgkmcnt(6)
  v_mfma_f32_16x16x32_bf16 v[72:75], v[148:151], v[116:119], v[72:75]
  ds_read_b64_tr_b16 v[162:163], v32 offset:22288
  v_mfma_f32_16x16x32_bf16 v[84:87], v[148:151], v[120:123], v[84:87]
  v_mfma_f32_16x16x32_bf16 v[96:99], v[148:151], v[124:127], v[96:99]
  s_waitcnt lgkmcnt(5)
  v_mfma_f32_16x16x32_bf16 v[64:67], v[152:155], v[120:123], v[64:67]
  ds_read_b64_tr_b16 v[140:141], v32 offset:24576
  v_mfma_f32_16x16x32_bf16 v[76:79], v[152:155], v[124:127], v[76:79]
  ds_read_b64_tr_b16 v[142:143], v32 offset:25344
  s_waitcnt lgkmcnt(6)
  v_mfma_f32_16x16x32_bf16 v[88:91], v[152:155], v[128:131], v[88:91]
  ds_read_b128 v[132:135], v16 offset:26112
  s_waitcnt lgkmcnt(5)
  v_mfma_f32_16x16x32_bf16 v[68:71], v[156:159], v[120:123], v[68:71]
  ds_read_b64_tr_b16 v[144:145], v32 offset:24584
  v_mfma_f32_16x16x32_bf16 v[80:83], v[156:159], v[124:127], v[80:83]
  ds_read_b64_tr_b16 v[146:147], v32 offset:25352
  v_mfma_f32_16x16x32_bf16 v[92:95], v[156:159], v[128:131], v[92:95]
  ds_read_b64_tr_b16 v[148:149], v32 offset:24592
  s_waitcnt lgkmcnt(6)
  v_mfma_f32_16x16x32_bf16 v[72:75], v[160:163], v[120:123], v[72:75]
  ds_read_b64_tr_b16 v[150:151], v32 offset:25360
  v_mfma_f32_16x16x32_bf16 v[84:87], v[160:163], v[124:127], v[84:87]
  v_mfma_f32_16x16x32_bf16 v[96:99], v[160:163], v[128:131], v[96:99]
  s_waitcnt lgkmcnt(5)
  v_mfma_f32_16x16x32_bf16 v[64:67], v[140:143], v[124:127], v[64:67]
  s_barrier
  ds_read_b64_tr_b16 v[152:153], v32 offset:27648
  ds_read_b64_tr_b16 v[154:155], v32 offset:28416
  v_mfma_f32_16x16x32_bf16 v[76:79], v[140:143], v[128:131], v[76:79]
  ds_read_b128 v[100:103], v24 offset:25600
  s_waitcnt lgkmcnt(7)
  v_mfma_f32_16x16x32_bf16 v[88:91], v[140:143], v[132:135], v[88:91]
  ds_read_b128 v[164:167], v52 offset:25600
  s_waitcnt lgkmcnt(6)
  v_mfma_f32_16x16x32_bf16 v[68:71], v[144:147], v[124:127], v[68:71]
  ds_read_b128 v[168:171], v53 offset:26112
  v_mfma_f32_16x16x32_bf16 v[80:83], v[144:147], v[128:131], v[80:83]
  ds_read_b128 v[172:175], v54 offset:26112
  v_mfma_f32_16x16x32_bf16 v[92:95], v[144:147], v[132:135], v[92:95]
  ds_read_b64_tr_b16 v[156:157], v32 offset:27656
  s_waitcnt lgkmcnt(7)
  v_mfma_f32_16x16x32_bf16 v[72:75], v[148:151], v[124:127], v[72:75]
  ds_read_b64_tr_b16 v[158:159], v32 offset:28424
  v_mfma_f32_16x16x32_bf16 v[84:87], v[148:151], v[128:131], v[84:87]
  ds_read_b64_tr_b16 v[160:161], v32 offset:27664
  v_mfma_f32_16x16x32_bf16 v[96:99], v[148:151], v[132:135], v[96:99]
  ds_read_b64_tr_b16 v[162:163], v32 offset:28432
  s_waitcnt lgkmcnt(6)
  v_mfma_f32_16x16x32_bf16 v[64:67], v[152:155], v[164:167], v[64:67]
  ds_read_b64_tr_b16 v[140:141], v32 offset:30720
  s_waitcnt lgkmcnt(6)
  v_mfma_f32_16x16x32_bf16 v[76:79], v[152:155], v[168:171], v[76:79]
  ds_read_b64_tr_b16 v[142:143], v32 offset:31488
  s_waitcnt lgkmcnt(6)
  v_mfma_f32_16x16x32_bf16 v[88:91], v[152:155], v[172:175], v[88:91]
  ds_read_b128 v[104:107], v25 offset:25600
  s_waitcnt lgkmcnt(5)
  v_mfma_f32_16x16x32_bf16 v[68:71], v[156:159], v[164:167], v[68:71]
  ds_read_b128 v[108:111], v26 offset:25600
  v_mfma_f32_16x16x32_bf16 v[80:83], v[156:159], v[168:171], v[80:83]
  ds_read_b64_tr_b16 v[144:145], v32 offset:30728
  v_mfma_f32_16x16x32_bf16 v[92:95], v[156:159], v[172:175], v[92:95]
  ds_read_b64_tr_b16 v[146:147], v32 offset:31496
  s_waitcnt lgkmcnt(6)
  v_mfma_f32_16x16x32_bf16 v[72:75], v[160:163], v[164:167], v[72:75]
  ds_read_b64_tr_b16 v[148:149], v32 offset:30736
  v_mfma_f32_16x16x32_bf16 v[84:87], v[160:163], v[168:171], v[84:87]
  ds_read_b64_tr_b16 v[150:151], v32 offset:31504
  v_mfma_f32_16x16x32_bf16 v[96:99], v[160:163], v[172:175], v[96:99]
  s_waitcnt lgkmcnt(6)
  v_mfma_f32_16x16x32_bf16 v[64:67], v[140:143], v[100:103], v[64:67]
  ds_read_b64_tr_b16 v[152:153], v32 offset:33792
  s_waitcnt lgkmcnt(6)
  v_mfma_f32_16x16x32_bf16 v[76:79], v[140:143], v[104:107], v[76:79]
  ds_read_b64_tr_b16 v[154:155], v32 offset:34560
  s_waitcnt lgkmcnt(6)
  v_mfma_f32_16x16x32_bf16 v[88:91], v[140:143], v[108:111], v[88:91]
  ds_read_b128 v[112:115], v27 offset:25600
  s_waitcnt lgkmcnt(5)
  v_mfma_f32_16x16x32_bf16 v[68:71], v[144:147], v[100:103], v[68:71]
  ds_read_b64_tr_b16 v[156:157], v32 offset:33800
  v_mfma_f32_16x16x32_bf16 v[80:83], v[144:147], v[104:107], v[80:83]
  ds_read_b64_tr_b16 v[158:159], v32 offset:34568
  v_mfma_f32_16x16x32_bf16 v[92:95], v[144:147], v[108:111], v[92:95]
  ds_read_b64_tr_b16 v[160:161], v32 offset:33808
  s_waitcnt lgkmcnt(6)
  v_mfma_f32_16x16x32_bf16 v[72:75], v[148:151], v[100:103], v[72:75]
  ds_read_b64_tr_b16 v[162:163], v32 offset:34576
  v_mfma_f32_16x16x32_bf16 v[84:87], v[148:151], v[104:107], v[84:87]
  v_mfma_f32_16x16x32_bf16 v[96:99], v[148:151], v[108:111], v[96:99]
  s_waitcnt lgkmcnt(5)
  v_mfma_f32_16x16x32_bf16 v[64:67], v[152:155], v[104:107], v[64:67]
  s_barrier
  ds_read_b64_tr_b16 v[140:141], v32 offset:36864
  v_mfma_f32_16x16x32_bf16 v[76:79], v[152:155], v[108:111], v[76:79]
  ds_read_b64_tr_b16 v[142:143], v32 offset:37632
  s_waitcnt lgkmcnt(6)
  v_mfma_f32_16x16x32_bf16 v[88:91], v[152:155], v[112:115], v[88:91]
  ds_read_b128 v[116:119], v28 offset:25600
  s_waitcnt lgkmcnt(5)
  v_mfma_f32_16x16x32_bf16 v[68:71], v[156:159], v[104:107], v[68:71]
  ds_read_b64_tr_b16 v[144:145], v32 offset:36872
  v_mfma_f32_16x16x32_bf16 v[80:83], v[156:159], v[108:111], v[80:83]
  ds_read_b64_tr_b16 v[146:147], v32 offset:37640
  v_mfma_f32_16x16x32_bf16 v[92:95], v[156:159], v[112:115], v[92:95]
  ds_read_b64_tr_b16 v[148:149], v32 offset:36880
  s_waitcnt lgkmcnt(6)
  v_mfma_f32_16x16x32_bf16 v[72:75], v[160:163], v[104:107], v[72:75]
  ds_read_b64_tr_b16 v[150:151], v32 offset:37648
  v_mfma_f32_16x16x32_bf16 v[84:87], v[160:163], v[108:111], v[84:87]
  v_mfma_f32_16x16x32_bf16 v[96:99], v[160:163], v[112:115], v[96:99]
  s_waitcnt lgkmcnt(5)
  v_mfma_f32_16x16x32_bf16 v[64:67], v[140:143], v[108:111], v[64:67]
  ds_read_b64_tr_b16 v[152:153], v32 offset:39936
  v_mfma_f32_16x16x32_bf16 v[76:79], v[140:143], v[112:115], v[76:79]
  ds_read_b64_tr_b16 v[154:155], v32 offset:40704
  s_waitcnt lgkmcnt(6)
  v_mfma_f32_16x16x32_bf16 v[88:91], v[140:143], v[116:119], v[88:91]
  ds_read_b128 v[120:123], v29 offset:25600
  s_waitcnt lgkmcnt(5)
  v_mfma_f32_16x16x32_bf16 v[68:71], v[144:147], v[108:111], v[68:71]
  ds_read_b64_tr_b16 v[156:157], v32 offset:39944
  v_mfma_f32_16x16x32_bf16 v[80:83], v[144:147], v[112:115], v[80:83]
  ds_read_b64_tr_b16 v[158:159], v32 offset:40712
  v_mfma_f32_16x16x32_bf16 v[92:95], v[144:147], v[116:119], v[92:95]
  ds_read_b64_tr_b16 v[160:161], v32 offset:39952
  s_waitcnt lgkmcnt(6)
  v_mfma_f32_16x16x32_bf16 v[72:75], v[148:151], v[108:111], v[72:75]
  ds_read_b64_tr_b16 v[162:163], v32 offset:40720
  v_mfma_f32_16x16x32_bf16 v[84:87], v[148:151], v[112:115], v[84:87]
  v_mfma_f32_16x16x32_bf16 v[96:99], v[148:151], v[116:119], v[96:99]
  s_waitcnt lgkmcnt(5)
  v_mfma_f32_16x16x32_bf16 v[64:67], v[152:155], v[112:115], v[64:67]
  ds_read_b64_tr_b16 v[140:141], v32 offset:43008
  v_mfma_f32_16x16x32_bf16 v[76:79], v[152:155], v[116:119], v[76:79]
  ds_read_b64_tr_b16 v[142:143], v32 offset:43776
  s_waitcnt lgkmcnt(6)
  v_mfma_f32_16x16x32_bf16 v[88:91], v[152:155], v[120:123], v[88:91]
  ds_read_b128 v[124:127], v30 offset:25600
  s_waitcnt lgkmcnt(5)
  v_mfma_f32_16x16x32_bf16 v[68:71], v[156:159], v[112:115], v[68:71]
  ds_read_b64_tr_b16 v[144:145], v32 offset:43016
  v_mfma_f32_16x16x32_bf16 v[80:83], v[156:159], v[116:119], v[80:83]
  ds_read_b64_tr_b16 v[146:147], v32 offset:43784
  v_mfma_f32_16x16x32_bf16 v[92:95], v[156:159], v[120:123], v[92:95]
  ds_read_b64_tr_b16 v[148:149], v32 offset:43024
  s_waitcnt lgkmcnt(6)
  v_mfma_f32_16x16x32_bf16 v[72:75], v[160:163], v[112:115], v[72:75]
  ds_read_b64_tr_b16 v[150:151], v32 offset:43792
  v_mfma_f32_16x16x32_bf16 v[84:87], v[160:163], v[116:119], v[84:87]
  v_mfma_f32_16x16x32_bf16 v[96:99], v[160:163], v[120:123], v[96:99]
  s_waitcnt lgkmcnt(5)
  v_mfma_f32_16x16x32_bf16 v[64:67], v[140:143], v[116:119], v[64:67]
  s_barrier
  ds_read_b64_tr_b16 v[152:153], v32 offset:0
  v_mfma_f32_16x16x32_bf16 v[76:79], v[140:143], v[120:123], v[76:79]
  ds_read_b64_tr_b16 v[154:155], v32 offset:768
  s_waitcnt lgkmcnt(6)
  v_mfma_f32_16x16x32_bf16 v[88:91], v[140:143], v[124:127], v[88:91]
  ds_read_b128 v[128:131], v31 offset:25600
  s_waitcnt lgkmcnt(5)
  v_mfma_f32_16x16x32_bf16 v[68:71], v[144:147], v[116:119], v[68:71]
  ds_read_b64_tr_b16 v[156:157], v32 offset:8
  v_mfma_f32_16x16x32_bf16 v[80:83], v[144:147], v[120:123], v[80:83]
  ds_read_b64_tr_b16 v[158:159], v32 offset:776
  v_mfma_f32_16x16x32_bf16 v[92:95], v[144:147], v[124:127], v[92:95]
  ds_read_b64_tr_b16 v[160:161], v32 offset:16
  s_waitcnt lgkmcnt(6)
  v_mfma_f32_16x16x32_bf16 v[72:75], v[148:151], v[116:119], v[72:75]
  ds_read_b64_tr_b16 v[162:163], v32 offset:784
  v_mfma_f32_16x16x32_bf16 v[84:87], v[148:151], v[120:123], v[84:87]
  v_mfma_f32_16x16x32_bf16 v[96:99], v[148:151], v[124:127], v[96:99]
  s_waitcnt lgkmcnt(5)
  v_mfma_f32_16x16x32_bf16 v[64:67], v[152:155], v[120:123], v[64:67]
  ds_read_b64_tr_b16 v[140:141], v32 offset:3072
  v_mfma_f32_16x16x32_bf16 v[76:79], v[152:155], v[124:127], v[76:79]
  ds_read_b64_tr_b16 v[142:143], v32 offset:3840
  s_waitcnt lgkmcnt(6)
  v_mfma_f32_16x16x32_bf16 v[88:91], v[152:155], v[128:131], v[88:91]
  ds_read_b128 v[132:135], v24 offset:26112
  s_waitcnt lgkmcnt(5)
  v_mfma_f32_16x16x32_bf16 v[68:71], v[156:159], v[120:123], v[68:71]
  ds_read_b128 v[100:103], v16 offset:38400
  v_mfma_f32_16x16x32_bf16 v[80:83], v[156:159], v[124:127], v[80:83]
  ds_read_b64_tr_b16 v[144:145], v32 offset:3080
  v_mfma_f32_16x16x32_bf16 v[92:95], v[156:159], v[128:131], v[92:95]
  ds_read_b64_tr_b16 v[146:147], v32 offset:3848
  s_waitcnt lgkmcnt(6)
  v_mfma_f32_16x16x32_bf16 v[72:75], v[160:163], v[120:123], v[72:75]
  ds_read_b64_tr_b16 v[148:149], v32 offset:3088
  v_mfma_f32_16x16x32_bf16 v[84:87], v[160:163], v[124:127], v[84:87]
  ds_read_b64_tr_b16 v[150:151], v32 offset:3856
  v_mfma_f32_16x16x32_bf16 v[96:99], v[160:163], v[128:131], v[96:99]
  s_waitcnt lgkmcnt(6)
  v_mfma_f32_16x16x32_bf16 v[64:67], v[140:143], v[124:127], v[64:67]
  ds_read_b64_tr_b16 v[152:153], v32 offset:6144
  v_mfma_f32_16x16x32_bf16 v[76:79], v[140:143], v[128:131], v[76:79]
  ds_read_b64_tr_b16 v[154:155], v32 offset:6912
  s_waitcnt lgkmcnt(7)
  v_mfma_f32_16x16x32_bf16 v[88:91], v[140:143], v[132:135], v[88:91]
  ds_read_b128 v[104:107], v17 offset:38400
  s_waitcnt lgkmcnt(5)
  v_mfma_f32_16x16x32_bf16 v[68:71], v[144:147], v[124:127], v[68:71]
  ds_read_b128 v[108:111], v18 offset:38400
  v_mfma_f32_16x16x32_bf16 v[80:83], v[144:147], v[128:131], v[80:83]
  ds_read_b64_tr_b16 v[156:157], v32 offset:6152
  v_mfma_f32_16x16x32_bf16 v[92:95], v[144:147], v[132:135], v[92:95]
  ds_read_b64_tr_b16 v[158:159], v32 offset:6920
  s_waitcnt lgkmcnt(6)
  v_mfma_f32_16x16x32_bf16 v[72:75], v[148:151], v[124:127], v[72:75]
  ds_read_b64_tr_b16 v[160:161], v32 offset:6160
  v_mfma_f32_16x16x32_bf16 v[84:87], v[148:151], v[128:131], v[84:87]
  ds_read_b64_tr_b16 v[162:163], v32 offset:6928
  v_mfma_f32_16x16x32_bf16 v[96:99], v[148:151], v[132:135], v[96:99]
  s_waitcnt lgkmcnt(6)
  v_mfma_f32_16x16x32_bf16 v[64:67], v[152:155], v[100:103], v[64:67]
  s_barrier
  ds_read_b64_tr_b16 v[140:141], v32 offset:9216
  s_waitcnt lgkmcnt(6)
  v_mfma_f32_16x16x32_bf16 v[76:79], v[152:155], v[104:107], v[76:79]
  ds_read_b64_tr_b16 v[142:143], v32 offset:9984
  s_waitcnt lgkmcnt(6)
  v_mfma_f32_16x16x32_bf16 v[88:91], v[152:155], v[108:111], v[88:91]
  ds_read_b128 v[112:115], v19 offset:38400
  s_waitcnt lgkmcnt(5)
  v_mfma_f32_16x16x32_bf16 v[68:71], v[156:159], v[100:103], v[68:71]
  ds_read_b64_tr_b16 v[144:145], v32 offset:9224
  v_mfma_f32_16x16x32_bf16 v[80:83], v[156:159], v[104:107], v[80:83]
  ds_read_b64_tr_b16 v[146:147], v32 offset:9992
  v_mfma_f32_16x16x32_bf16 v[92:95], v[156:159], v[108:111], v[92:95]
  ds_read_b64_tr_b16 v[148:149], v32 offset:9232
  s_waitcnt lgkmcnt(6)
  v_mfma_f32_16x16x32_bf16 v[72:75], v[160:163], v[100:103], v[72:75]
  ds_read_b64_tr_b16 v[150:151], v32 offset:10000
  v_mfma_f32_16x16x32_bf16 v[84:87], v[160:163], v[104:107], v[84:87]
  v_mfma_f32_16x16x32_bf16 v[96:99], v[160:163], v[108:111], v[96:99]
  s_waitcnt lgkmcnt(5)
  v_mfma_f32_16x16x32_bf16 v[64:67], v[140:143], v[104:107], v[64:67]
  ds_read_b64_tr_b16 v[152:153], v32 offset:12288
  v_mfma_f32_16x16x32_bf16 v[76:79], v[140:143], v[108:111], v[76:79]
  ds_read_b64_tr_b16 v[154:155], v32 offset:13056
  s_waitcnt lgkmcnt(6)
  v_mfma_f32_16x16x32_bf16 v[88:91], v[140:143], v[112:115], v[88:91]
  ds_read_b128 v[116:119], v20 offset:38400
  s_waitcnt lgkmcnt(5)
  v_mfma_f32_16x16x32_bf16 v[68:71], v[144:147], v[104:107], v[68:71]
  ds_read_b64_tr_b16 v[156:157], v32 offset:12296
  v_mfma_f32_16x16x32_bf16 v[80:83], v[144:147], v[108:111], v[80:83]
  ds_read_b64_tr_b16 v[158:159], v32 offset:13064
  v_mfma_f32_16x16x32_bf16 v[92:95], v[144:147], v[112:115], v[92:95]
  ds_read_b64_tr_b16 v[160:161], v32 offset:12304
  s_waitcnt lgkmcnt(6)
  v_mfma_f32_16x16x32_bf16 v[72:75], v[148:151], v[104:107], v[72:75]
  ds_read_b64_tr_b16 v[162:163], v32 offset:13072
  v_mfma_f32_16x16x32_bf16 v[84:87], v[148:151], v[108:111], v[84:87]
  v_mfma_f32_16x16x32_bf16 v[96:99], v[148:151], v[112:115], v[96:99]
  s_waitcnt lgkmcnt(5)
  v_mfma_f32_16x16x32_bf16 v[64:67], v[152:155], v[108:111], v[64:67]
  ds_read_b64_tr_b16 v[140:141], v32 offset:15360
  v_mfma_f32_16x16x32_bf16 v[76:79], v[152:155], v[112:115], v[76:79]
  ds_read_b64_tr_b16 v[142:143], v32 offset:16128
  s_waitcnt lgkmcnt(6)
  v_mfma_f32_16x16x32_bf16 v[88:91], v[152:155], v[116:119], v[88:91]
  ds_read_b128 v[120:123], v21 offset:38400
  s_waitcnt lgkmcnt(5)
  v_mfma_f32_16x16x32_bf16 v[68:71], v[156:159], v[108:111], v[68:71]
  ds_read_b64_tr_b16 v[144:145], v32 offset:15368
  v_mfma_f32_16x16x32_bf16 v[80:83], v[156:159], v[112:115], v[80:83]
  ds_read_b64_tr_b16 v[146:147], v32 offset:16136
  v_mfma_f32_16x16x32_bf16 v[92:95], v[156:159], v[116:119], v[92:95]
  ds_read_b64_tr_b16 v[148:149], v32 offset:15376
  s_waitcnt lgkmcnt(6)
  v_mfma_f32_16x16x32_bf16 v[72:75], v[160:163], v[108:111], v[72:75]
  ds_read_b64_tr_b16 v[150:151], v32 offset:16144
  v_mfma_f32_16x16x32_bf16 v[84:87], v[160:163], v[112:115], v[84:87]
  v_mfma_f32_16x16x32_bf16 v[96:99], v[160:163], v[116:119], v[96:99]
  s_waitcnt lgkmcnt(5)
  v_mfma_f32_16x16x32_bf16 v[64:67], v[140:143], v[112:115], v[64:67]
  s_barrier
  ds_read_b64_tr_b16 v[152:153], v32 offset:18432
  v_mfma_f32_16x16x32_bf16 v[76:79], v[140:143], v[116:119], v[76:79]
  ds_read_b64_tr_b16 v[154:155], v32 offset:19200
  s_waitcnt lgkmcnt(6)
  v_mfma_f32_16x16x32_bf16 v[88:91], v[140:143], v[120:123], v[88:91]
  ds_read_b128 v[124:127], v22 offset:38400
  s_waitcnt lgkmcnt(5)
  v_mfma_f32_16x16x32_bf16 v[68:71], v[144:147], v[112:115], v[68:71]
  ds_read_b64_tr_b16 v[156:157], v32 offset:18440
  v_mfma_f32_16x16x32_bf16 v[80:83], v[144:147], v[116:119], v[80:83]
  ds_read_b64_tr_b16 v[158:159], v32 offset:19208
  v_mfma_f32_16x16x32_bf16 v[92:95], v[144:147], v[120:123], v[92:95]
  ds_read_b64_tr_b16 v[160:161], v32 offset:18448
  s_waitcnt lgkmcnt(6)
  v_mfma_f32_16x16x32_bf16 v[72:75], v[148:151], v[112:115], v[72:75]
  ds_read_b64_tr_b16 v[162:163], v32 offset:19216
  v_mfma_f32_16x16x32_bf16 v[84:87], v[148:151], v[116:119], v[84:87]
  v_mfma_f32_16x16x32_bf16 v[96:99], v[148:151], v[120:123], v[96:99]
  s_waitcnt lgkmcnt(5)
  v_mfma_f32_16x16x32_bf16 v[64:67], v[152:155], v[116:119], v[64:67]
  ds_read_b64_tr_b16 v[140:141], v32 offset:21504
  v_mfma_f32_16x16x32_bf16 v[76:79], v[152:155], v[120:123], v[76:79]
  ds_read_b64_tr_b16 v[142:143], v32 offset:22272
  s_waitcnt lgkmcnt(6)
  v_mfma_f32_16x16x32_bf16 v[88:91], v[152:155], v[124:127], v[88:91]
  ds_read_b128 v[128:131], v23 offset:38400
  s_waitcnt lgkmcnt(5)
  v_mfma_f32_16x16x32_bf16 v[68:71], v[156:159], v[116:119], v[68:71]
  ds_read_b64_tr_b16 v[144:145], v32 offset:21512
  v_mfma_f32_16x16x32_bf16 v[80:83], v[156:159], v[120:123], v[80:83]
  ds_read_b64_tr_b16 v[146:147], v32 offset:22280
  v_mfma_f32_16x16x32_bf16 v[92:95], v[156:159], v[124:127], v[92:95]
  ds_read_b64_tr_b16 v[148:149], v32 offset:21520
  s_waitcnt lgkmcnt(6)
  v_mfma_f32_16x16x32_bf16 v[72:75], v[160:163], v[116:119], v[72:75]
  ds_read_b64_tr_b16 v[150:151], v32 offset:22288
  v_mfma_f32_16x16x32_bf16 v[84:87], v[160:163], v[120:123], v[84:87]
  v_mfma_f32_16x16x32_bf16 v[96:99], v[160:163], v[124:127], v[96:99]
  s_waitcnt lgkmcnt(5)
  v_mfma_f32_16x16x32_bf16 v[64:67], v[140:143], v[120:123], v[64:67]
  ds_read_b64_tr_b16 v[152:153], v32 offset:24576
  v_mfma_f32_16x16x32_bf16 v[76:79], v[140:143], v[124:127], v[76:79]
  ds_read_b64_tr_b16 v[154:155], v32 offset:25344
  s_waitcnt lgkmcnt(6)
  v_mfma_f32_16x16x32_bf16 v[88:91], v[140:143], v[128:131], v[88:91]
  ds_read_b128 v[132:135], v16 offset:38912
  s_waitcnt lgkmcnt(5)
  v_mfma_f32_16x16x32_bf16 v[68:71], v[144:147], v[120:123], v[68:71]
  ds_read_b128 v[100:103], v24 offset:38400
  v_mfma_f32_16x16x32_bf16 v[80:83], v[144:147], v[124:127], v[80:83]
  ds_read_b64_tr_b16 v[156:157], v32 offset:24584
  v_mfma_f32_16x16x32_bf16 v[92:95], v[144:147], v[128:131], v[92:95]
  ds_read_b64_tr_b16 v[158:159], v32 offset:25352
  s_waitcnt lgkmcnt(6)
  v_mfma_f32_16x16x32_bf16 v[72:75], v[148:151], v[120:123], v[72:75]
  ds_read_b64_tr_b16 v[160:161], v32 offset:24592
  v_mfma_f32_16x16x32_bf16 v[84:87], v[148:151], v[124:127], v[84:87]
  ds_read_b64_tr_b16 v[162:163], v32 offset:25360
  v_mfma_f32_16x16x32_bf16 v[96:99], v[148:151], v[128:131], v[96:99]
  s_waitcnt lgkmcnt(6)
  v_mfma_f32_16x16x32_bf16 v[64:67], v[152:155], v[124:127], v[64:67]
  s_barrier
  ds_read_b64_tr_b16 v[140:141], v32 offset:27648
  v_mfma_f32_16x16x32_bf16 v[76:79], v[152:155], v[128:131], v[76:79]
  ds_read_b64_tr_b16 v[142:143], v32 offset:28416
  s_waitcnt lgkmcnt(7)
  v_mfma_f32_16x16x32_bf16 v[88:91], v[152:155], v[132:135], v[88:91]
  ds_read_b128 v[104:107], v25 offset:38400
  s_waitcnt lgkmcnt(5)
  v_mfma_f32_16x16x32_bf16 v[68:71], v[156:159], v[124:127], v[68:71]
  ds_read_b128 v[108:111], v26 offset:38400
  v_mfma_f32_16x16x32_bf16 v[80:83], v[156:159], v[128:131], v[80:83]
  ds_read_b64_tr_b16 v[144:145], v32 offset:27656
  v_mfma_f32_16x16x32_bf16 v[92:95], v[156:159], v[132:135], v[92:95]
  ds_read_b64_tr_b16 v[146:147], v32 offset:28424
  s_waitcnt lgkmcnt(6)
  v_mfma_f32_16x16x32_bf16 v[72:75], v[160:163], v[124:127], v[72:75]
  ds_read_b64_tr_b16 v[148:149], v32 offset:27664
  v_mfma_f32_16x16x32_bf16 v[84:87], v[160:163], v[128:131], v[84:87]
  ds_read_b64_tr_b16 v[150:151], v32 offset:28432
  v_mfma_f32_16x16x32_bf16 v[96:99], v[160:163], v[132:135], v[96:99]
  s_waitcnt lgkmcnt(6)
  v_mfma_f32_16x16x32_bf16 v[64:67], v[140:143], v[100:103], v[64:67]
  ds_read_b64_tr_b16 v[152:153], v32 offset:30720
  s_waitcnt lgkmcnt(6)
  v_mfma_f32_16x16x32_bf16 v[76:79], v[140:143], v[104:107], v[76:79]
  ds_read_b64_tr_b16 v[154:155], v32 offset:31488
  s_waitcnt lgkmcnt(6)
  v_mfma_f32_16x16x32_bf16 v[88:91], v[140:143], v[108:111], v[88:91]
  ds_read_b128 v[112:115], v27 offset:38400
  s_waitcnt lgkmcnt(5)
  v_mfma_f32_16x16x32_bf16 v[68:71], v[144:147], v[100:103], v[68:71]
  ds_read_b64_tr_b16 v[156:157], v32 offset:30728
  v_mfma_f32_16x16x32_bf16 v[80:83], v[144:147], v[104:107], v[80:83]
  ds_read_b64_tr_b16 v[158:159], v32 offset:31496
  v_mfma_f32_16x16x32_bf16 v[92:95], v[144:147], v[108:111], v[92:95]
  ds_read_b64_tr_b16 v[160:161], v32 offset:30736
  s_waitcnt lgkmcnt(6)
  v_mfma_f32_16x16x32_bf16 v[72:75], v[148:151], v[100:103], v[72:75]
  ds_read_b64_tr_b16 v[162:163], v32 offset:31504
  v_mfma_f32_16x16x32_bf16 v[84:87], v[148:151], v[104:107], v[84:87]
  v_mfma_f32_16x16x32_bf16 v[96:99], v[148:151], v[108:111], v[96:99]
  s_waitcnt lgkmcnt(5)
  v_mfma_f32_16x16x32_bf16 v[64:67], v[152:155], v[104:107], v[64:67]
  ds_read_b64_tr_b16 v[140:141], v32 offset:33792
  v_mfma_f32_16x16x32_bf16 v[76:79], v[152:155], v[108:111], v[76:79]
  ds_read_b64_tr_b16 v[142:143], v32 offset:34560
  s_waitcnt lgkmcnt(6)
  v_mfma_f32_16x16x32_bf16 v[88:91], v[152:155], v[112:115], v[88:91]
  ds_read_b128 v[116:119], v28 offset:38400
  s_waitcnt lgkmcnt(5)
  v_mfma_f32_16x16x32_bf16 v[68:71], v[156:159], v[104:107], v[68:71]
  ds_read_b64_tr_b16 v[144:145], v32 offset:33800
  v_mfma_f32_16x16x32_bf16 v[80:83], v[156:159], v[108:111], v[80:83]
  ds_read_b64_tr_b16 v[146:147], v32 offset:34568
  v_mfma_f32_16x16x32_bf16 v[92:95], v[156:159], v[112:115], v[92:95]
  ds_read_b64_tr_b16 v[148:149], v32 offset:33808
  s_waitcnt lgkmcnt(6)
  v_mfma_f32_16x16x32_bf16 v[72:75], v[160:163], v[104:107], v[72:75]
  ds_read_b64_tr_b16 v[150:151], v32 offset:34576
  v_mfma_f32_16x16x32_bf16 v[84:87], v[160:163], v[108:111], v[84:87]
  v_mfma_f32_16x16x32_bf16 v[96:99], v[160:163], v[112:115], v[96:99]
  s_waitcnt lgkmcnt(5)
  v_mfma_f32_16x16x32_bf16 v[64:67], v[140:143], v[108:111], v[64:67]
  s_barrier
  ds_read_b64_tr_b16 v[152:153], v32 offset:36864
  v_mfma_f32_16x16x32_bf16 v[76:79], v[140:143], v[112:115], v[76:79]
  ds_read_b64_tr_b16 v[154:155], v32 offset:37632
  s_waitcnt lgkmcnt(6)
  v_mfma_f32_16x16x32_bf16 v[88:91], v[140:143], v[116:119], v[88:91]
  ds_read_b128 v[120:123], v29 offset:38400
  s_waitcnt lgkmcnt(5)
  v_mfma_f32_16x16x32_bf16 v[68:71], v[144:147], v[108:111], v[68:71]
  ds_read_b64_tr_b16 v[156:157], v32 offset:36872
  v_mfma_f32_16x16x32_bf16 v[80:83], v[144:147], v[112:115], v[80:83]
  ds_read_b64_tr_b16 v[158:159], v32 offset:37640
  v_mfma_f32_16x16x32_bf16 v[92:95], v[144:147], v[116:119], v[92:95]
  ds_read_b64_tr_b16 v[160:161], v32 offset:36880
  s_waitcnt lgkmcnt(6)
  v_mfma_f32_16x16x32_bf16 v[72:75], v[148:151], v[108:111], v[72:75]
  ds_read_b64_tr_b16 v[162:163], v32 offset:37648
  v_mfma_f32_16x16x32_bf16 v[84:87], v[148:151], v[112:115], v[84:87]
  v_mfma_f32_16x16x32_bf16 v[96:99], v[148:151], v[116:119], v[96:99]
  s_waitcnt lgkmcnt(5)
  v_mfma_f32_16x16x32_bf16 v[64:67], v[152:155], v[112:115], v[64:67]
  ds_read_b64_tr_b16 v[140:141], v32 offset:39936
  v_mfma_f32_16x16x32_bf16 v[76:79], v[152:155], v[116:119], v[76:79]
  ds_read_b64_tr_b16 v[142:143], v32 offset:40704
  s_waitcnt lgkmcnt(6)
  v_mfma_f32_16x16x32_bf16 v[88:91], v[152:155], v[120:123], v[88:91]
  ds_read_b128 v[124:127], v30 offset:38400
  s_waitcnt lgkmcnt(5)
  v_mfma_f32_16x16x32_bf16 v[68:71], v[156:159], v[112:115], v[68:71]
  ds_read_b64_tr_b16 v[144:145], v32 offset:39944
  v_mfma_f32_16x16x32_bf16 v[80:83], v[156:159], v[116:119], v[80:83]
  ds_read_b64_tr_b16 v[146:147], v32 offset:40712
  v_mfma_f32_16x16x32_bf16 v[92:95], v[156:159], v[120:123], v[92:95]
  ds_read_b64_tr_b16 v[148:149], v32 offset:39952
  s_waitcnt lgkmcnt(6)
  v_mfma_f32_16x16x32_bf16 v[72:75], v[160:163], v[112:115], v[72:75]
  ds_read_b64_tr_b16 v[150:151], v32 offset:40720
  v_mfma_f32_16x16x32_bf16 v[84:87], v[160:163], v[116:119], v[84:87]
  v_mfma_f32_16x16x32_bf16 v[96:99], v[160:163], v[120:123], v[96:99]
  s_waitcnt lgkmcnt(5)
  v_mfma_f32_16x16x32_bf16 v[64:67], v[140:143], v[116:119], v[64:67]
  ds_read_b64_tr_b16 v[152:153], v32 offset:43008
  v_mfma_f32_16x16x32_bf16 v[76:79], v[140:143], v[120:123], v[76:79]
  ds_read_b64_tr_b16 v[154:155], v32 offset:43776
  s_waitcnt lgkmcnt(6)
  v_mfma_f32_16x16x32_bf16 v[88:91], v[140:143], v[124:127], v[88:91]
  ds_read_b128 v[128:131], v31 offset:38400
  s_waitcnt lgkmcnt(5)
  v_mfma_f32_16x16x32_bf16 v[68:71], v[144:147], v[116:119], v[68:71]
  ds_read_b64_tr_b16 v[156:157], v32 offset:43016
  v_mfma_f32_16x16x32_bf16 v[80:83], v[144:147], v[120:123], v[80:83]
  ds_read_b64_tr_b16 v[158:159], v32 offset:43784
  v_mfma_f32_16x16x32_bf16 v[92:95], v[144:147], v[124:127], v[92:95]
  ds_read_b64_tr_b16 v[160:161], v32 offset:43024
  s_waitcnt lgkmcnt(6)
  v_mfma_f32_16x16x32_bf16 v[72:75], v[148:151], v[116:119], v[72:75]
  ds_read_b64_tr_b16 v[162:163], v32 offset:43792
  v_mfma_f32_16x16x32_bf16 v[84:87], v[148:151], v[120:123], v[84:87]
  v_mfma_f32_16x16x32_bf16 v[96:99], v[148:151], v[124:127], v[96:99]
  s_waitcnt lgkmcnt(5)
  v_mfma_f32_16x16x32_bf16 v[64:67], v[152:155], v[120:123], v[64:67]
  ds_read_b64_tr_b16 v[140:141], v32 offset:0
  v_mfma_f32_16x16x32_bf16 v[76:79], v[152:155], v[124:127], v[76:79]
  ds_read_b64_tr_b16 v[142:143], v32 offset:768
  s_waitcnt lgkmcnt(6)
  v_mfma_f32_16x16x32_bf16 v[88:91], v[152:155], v[128:131], v[88:91]
  ds_read_b128 v[132:135], v24 offset:38912
  s_waitcnt lgkmcnt(5)
  v_mfma_f32_16x16x32_bf16 v[68:71], v[156:159], v[120:123], v[68:71]
  ds_read_b128 v[100:103], v16 offset:51200
  v_mfma_f32_16x16x32_bf16 v[80:83], v[156:159], v[124:127], v[80:83]
  ds_read_b64_tr_b16 v[144:145], v32 offset:8
  v_mfma_f32_16x16x32_bf16 v[92:95], v[156:159], v[128:131], v[92:95]
  ds_read_b64_tr_b16 v[146:147], v32 offset:776
  s_waitcnt lgkmcnt(6)
  v_mfma_f32_16x16x32_bf16 v[72:75], v[160:163], v[120:123], v[72:75]
  ds_read_b64_tr_b16 v[148:149], v32 offset:16
  v_mfma_f32_16x16x32_bf16 v[84:87], v[160:163], v[124:127], v[84:87]
  ds_read_b64_tr_b16 v[150:151], v32 offset:784
  v_mfma_f32_16x16x32_bf16 v[96:99], v[160:163], v[128:131], v[96:99]
  s_waitcnt lgkmcnt(6)
  v_mfma_f32_16x16x32_bf16 v[64:67], v[140:143], v[124:127], v[64:67]
  s_barrier
  ds_read_b64_tr_b16 v[152:153], v32 offset:3072
  ds_read_b64_tr_b16 v[154:155], v32 offset:3840
  v_mfma_f32_16x16x32_bf16 v[76:79], v[140:143], v[128:131], v[76:79]
  ds_read_b128 v[104:107], v17 offset:51200
  s_waitcnt lgkmcnt(8)
  v_mfma_f32_16x16x32_bf16 v[88:91], v[140:143], v[132:135], v[88:91]
  ds_read_b128 v[108:111], v18 offset:51200
  s_waitcnt lgkmcnt(6)
  v_mfma_f32_16x16x32_bf16 v[68:71], v[144:147], v[124:127], v[68:71]
  ds_read_b128 v[112:115], v19 offset:51200
  v_mfma_f32_16x16x32_bf16 v[80:83], v[144:147], v[128:131], v[80:83]
  ds_read_b128 v[116:119], v20 offset:51200
  v_mfma_f32_16x16x32_bf16 v[92:95], v[144:147], v[132:135], v[92:95]
  ds_read_b64_tr_b16 v[156:157], v32 offset:6144
  s_waitcnt lgkmcnt(7)
  v_mfma_f32_16x16x32_bf16 v[72:75], v[148:151], v[124:127], v[72:75]
  ds_read_b64_tr_b16 v[158:159], v32 offset:6912
  v_mfma_f32_16x16x32_bf16 v[84:87], v[148:151], v[128:131], v[84:87]
  ds_read_b64_tr_b16 v[160:161], v32 offset:9216
  v_mfma_f32_16x16x32_bf16 v[96:99], v[148:151], v[132:135], v[96:99]
  ds_read_b64_tr_b16 v[162:163], v32 offset:9984
  s_waitcnt lgkmcnt(8)
  v_mfma_f32_16x16x32_bf16 v[64:67], v[152:155], v[100:103], v[64:67]
  ds_read_b128 v[120:123], v21 offset:51200
  s_waitcnt lgkmcnt(8)
  v_mfma_f32_16x16x32_bf16 v[76:79], v[152:155], v[104:107], v[76:79]
  ds_read_b64_tr_b16 v[140:141], v32 offset:12288
  s_waitcnt lgkmcnt(8)
  v_mfma_f32_16x16x32_bf16 v[88:91], v[152:155], v[108:111], v[88:91]
L_hop2:
  s_cbranch_execz L_wr
  ds_read_b64_tr_b16 v[142:143], v32 offset:13056
  s_waitcnt lgkmcnt(5)
  v_mfma_f32_16x16x32_bf16 v[64:67], v[156:159], v[104:107], v[64:67]
  ds_read_b128 v[124:127], v22 offset:51200
  v_mfma_f32_16x16x32_bf16 v[76:79], v[156:159], v[108:111], v[76:79]
  ds_read_b64_tr_b16 v[144:145], v32 offset:15360
  v_mfma_f32_16x16x32_bf16 v[88:91], v[156:159], v[112:115], v[88:91]
  ds_read_b64_tr_b16 v[146:147], v32 offset:16128
  s_waitcnt lgkmcnt(6)
  v_mfma_f32_16x16x32_bf16 v[64:67], v[160:163], v[108:111], v[64:67]
  ds_read_b128 v[128:131], v23 offset:51200
  v_mfma_f32_16x16x32_bf16 v[76:79], v[160:163], v[112:115], v[76:79]
  ds_read_b64_tr_b16 v[148:149], v32 offset:18432
  v_mfma_f32_16x16x32_bf16 v[88:91], v[160:163], v[116:119], v[88:91]
  ds_read_b64_tr_b16 v[150:151], v32 offset:19200
  s_waitcnt lgkmcnt(6)
  v_mfma_f32_16x16x32_bf16 v[64:67], v[140:143], v[112:115], v[64:67]
  ds_read_b128 v[132:135], v16 offset:51712
  v_mfma_f32_16x16x32_bf16 v[76:79], v[140:143], v[116:119], v[76:79]
  ds_read_b64_tr_b16 v[152:153], v32 offset:21504
  v_mfma_f32_16x16x32_bf16 v[88:91], v[140:143], v[120:123], v[88:91]
  ds_read_b64_tr_b16 v[154:155], v32 offset:22272
  s_waitcnt lgkmcnt(6)
  v_mfma_f32_16x16x32_bf16 v[64:67], v[144:147], v[116:119], v[64:67]
  ds_read_b64_tr_b16 v[156:157], v32 offset:3080
  v_mfma_f32_16x16x32_bf16 v[76:79], v[144:147], v[120:123], v[76:79]
  ds_read_b64_tr_b16 v[158:159], v32 offset:3848
  v_mfma_f32_16x16x32_bf16 v[88:91], v[144:147], v[124:127], v[88:91]
  s_waitcnt lgkmcnt(5)
  v_mfma_f32_16x16x32_bf16 v[64:67], v[148:151], v[120:123], v[64:67]
  ds_read_b64_tr_b16 v[160:161], v32 offset:6152
  v_mfma_f32_16x16x32_bf16 v[76:79], v[148:151], v[124:127], v[76:79]
  ds_read_b64_tr_b16 v[162:163], v32 offset:6920
  v_mfma_f32_16x16x32_bf16 v[88:91], v[148:151], v[128:131], v[88:91]
  s_waitcnt lgkmcnt(4)
  v_mfma_f32_16x16x32_bf16 v[64:67], v[152:155], v[124:127], v[64:67]
  ds_read_b64_tr_b16 v[140:141], v32 offset:9224
  v_mfma_f32_16x16x32_bf16 v[76:79], v[152:155], v[128:131], v[76:79]
  ds_read_b64_tr_b16 v[142:143], v32 offset:9992
  v_mfma_f32_16x16x32_bf16 v[88:91], v[152:155], v[132:135], v[88:91]
  s_waitcnt lgkmcnt(4)
  v_mfma_f32_16x16x32_bf16 v[68:71], v[156:159], v[100:103], v[68:71]
  ds_read_b64_tr_b16 v[144:145], v32 offset:12296
  v_mfma_f32_16x16x32_bf16 v[80:83], v[156:159], v[104:107], v[80:83]
  ds_read_b64_tr_b16 v[146:147], v32 offset:13064
  v_mfma_f32_16x16x32_bf16 v[92:95], v[156:159], v[108:111], v[92:95]
  s_cmp_lg_u32 s24, 41
  s_cbranch_scc1 L_nomask0
  s_mov_b64 exec, s[40:41]
  v_mov_b32 v64, 0
  v_mov_b32 v65, 0
  v_mov_b32 v66, 0
  v_mov_b32 v67, 0
  s_mov_b64 exec, s[42:43]
  v_mov_b32 v76, 0
  v_mov_b32 v77, 0
  v_mov_b32 v78, 0
  v_mov_b32 v79, 0
  s_mov_b64 exec, s[44:45]
  v_mov_b32 v88, 0
  v_mov_b32 v89, 0
  v_mov_b32 v90, 0
  v_mov_b32 v91, 0
  s_mov_b64 exec, -1
L_nomask0:
  s_waitcnt lgkmcnt(4)
  v_mfma_f32_16x16x32_bf16 v[68:71], v[160:163], v[104:107], v[68:71]
  ds_read_b64_tr_b16 v[148:149], v32 offset:15368
  v_add_f32 v176, v64, v76
  v_add_f32 v177, v65, v77
  v_add_f32 v178, v66, v78
  v_add_f32 v179, v67, v79
  v_mul_f32 v180, v64, v64
  v_mfma_f32_16x16x32_bf16 v[80:83], v[160:163], v[108:111], v[80:83]
  ds_read_b64_tr_b16 v[150:151], v32 offset:16136
  v_mul_f32 v181, v65, v65
  v_mul_f32 v182, v66, v66
  v_mul_f32 v183, v67, v67
  v_fmac_f32 v180, v76, v76
  v_fmac_f32 v181, v77, v77
  v_mfma_f32_16x16x32_bf16 v[92:95], v[160:163], v[112:115], v[92:95]
  v_fmac_f32 v182, v78, v78
  v_fmac_f32 v183, v79, v79
  v_add_f32 v176, v176, v88
  v_add_f32 v177, v177, v89
  v_add_f32 v178, v178, v90
  s_waitcnt lgkmcnt(4)
  v_mfma_f32_16x16x32_bf16 v[68:71], v[140:143], v[108:111], v[68:71]
  ds_read_b64_tr_b16 v[152:153], v32 offset:18440
  v_add_f32 v179, v179, v91
  v_fmac_f32 v180, v88, v88
  v_fmac_f32 v181, v89, v89
  v_fmac_f32 v182, v90, v90
  v_fmac_f32 v183, v91, v91
  v_mfma_f32_16x16x32_bf16 v[80:83], v[140:143], v[112:115], v[80:83]
  ds_read_b64_tr_b16 v[154:155], v32 offset:19208
  v_add_f32_dpp v184, v176, v176 row_ror:8 row_mask:0xf bank_mask:0xf
  v_add_f32_dpp v185, v177, v177 row_ror:8 row_mask:0xf bank_mask:0xf
  v_add_f32_dpp v186, v180, v180 row_ror:8 row_mask:0xf bank_mask:0xf
  v_add_f32_dpp v187, v181, v181 row_ror:8 row_mask:0xf bank_mask:0xf
  v_add_f32_dpp v184, v178, v178 row_ror:8 row_mask:0xf bank_mask:0xc
  v_mfma_f32_16x16x32_bf16 v[92:95], v[140:143], v[116:119], v[92:95]
  v_add_f32_dpp v185, v179, v179 row_ror:8 row_mask:0xf bank_mask:0xc
  v_add_f32_dpp v186, v182, v182 row_ror:8 row_mask:0xf bank_mask:0xc
  v_add_f32_dpp v187, v183, v183 row_ror:8 row_mask:0xf bank_mask:0xc
  v_add_f32_dpp v176, v184, v184 row_half_mirror row_mask:0xf bank_mask:0xf
  v_add_f32_dpp v180, v186, v186 row_half_mirror row_mask:0xf bank_mask:0xf
  s_waitcnt lgkmcnt(4)
  v_mfma_f32_16x16x32_bf16 v[68:71], v[144:147], v[112:115], v[68:71]
  ds_read_b64_tr_b16 v[156:157], v32 offset:21512
  s_nop 0
  v_add_f32_dpp v176, v185, v185 row_half_mirror row_mask:0xf bank_mask:0xa
  v_add_f32_dpp v180, v187, v187 row_half_mirror row_mask:0xf bank_mask:0xa
  s_nop 0
  v_mfma_f32_16x16x32_bf16 v[80:83], v[144:147], v[116:119], v[80:83]
  ds_read_b64_tr_b16 v[158:159], v32 offset:22280
  v_add_f32_dpp v177, v176, v176 quad_perm:[1,0,3,2] row_mask:0xf bank_mask:0xf
  v_add_f32_dpp v181, v180, v180 quad_perm:[1,0,3,2] row_mask:0xf bank_mask:0xf
  s_nop 0
  v_add_f32_dpp v176, v177, v177 quad_perm:[2,3,0,1] row_mask:0xf bank_mask:0xf
  v_mfma_f32_16x16x32_bf16 v[92:95], v[144:147], v[120:123], v[92:95]
  v_add_f32_dpp v180, v181, v181 quad_perm:[2,3,0,1] row_mask:0xf bank_mask:0xf
  ds_write_b32 v33, v176 offset:0
  ds_write_b32 v33, v180 offset:16
  ds_write_b32 v34, v35 offset:0
  s_waitcnt lgkmcnt(7)
  v_mfma_f32_16x16x32_bf16 v[68:71], v[148:151], v[116:119], v[68:71]
  ds_read_b64_tr_b16 v[160:161], v32 offset:3088
  v_mfma_f32_16x16x32_bf16 v[80:83], v[148:151], v[120:123], v[80:83]
  ds_read_b64_tr_b16 v[162:163], v32 offset:3856
  v_mfma_f32_16x16x32_bf16 v[92:95], v[148:151], v[124:127], v[92:95]
  s_waitcnt lgkmcnt(7)
  v_mfma_f32_16x16x32_bf16 v[68:71], v[152:155], v[120:123], v[68:71]
  ds_read_b64_tr_b16 v[140:141], v32 offset:6160
  v_mfma_f32_16x16x32_bf16 v[80:83], v[152:155], v[124:127], v[80:83]
  ds_read_b64_tr_b16 v[142:143], v32 offset:6928
  v_mfma_f32_16x16x32_bf16 v[92:95], v[152:155], v[128:131], v[92:95]
  s_waitcnt lgkmcnt(7)
  v_mfma_f32_16x16x32_bf16 v[68:71], v[156:159], v[124:127], v[68:71]
  ds_read_b64_tr_b16 v[144:145], v32 offset:9232
  v_mfma_f32_16x16x32_bf16 v[80:83], v[156:159], v[128:131], v[80:83]
  ds_read_b64_tr_b16 v[146:147], v32 offset:10000
  v_mfma_f32_16x16x32_bf16 v[92:95], v[156:159], v[132:135], v[92:95]
  s_waitcnt lgkmcnt(4)
  v_mfma_f32_16x16x32_bf16 v[72:75], v[160:163], v[100:103], v[72:75]
  ds_read_b64_tr_b16 v[148:149], v32 offset:12304
  v_mfma_f32_16x16x32_bf16 v[84:87], v[160:163], v[104:107], v[84:87]
  ds_read_b64_tr_b16 v[150:151], v32 offset:13072
  v_mfma_f32_16x16x32_bf16 v[96:99], v[160:163], v[108:111], v[96:99]
  s_cmp_lg_u32 s24, 41
  s_cbranch_scc1 L_nomask1
  s_mov_b64 exec, s[40:41]
  v_mov_b32 v68, 0
  v_mov_b32 v69, 0
  v_mov_b32 v70, 0
  v_mov_b32 v71, 0
  s_mov_b64 exec, s[42:43]
  v_mov_b32 v80, 0
  v_mov_b32 v81, 0
  v_mov_b32 v82, 0
  v_mov_b32 v83, 0
  s_mov_b64 exec, s[44:45]
  v_mov_b32 v92, 0
  v_mov_b32 v93, 0
  v_mov_b32 v94, 0
  v_mov_b32 v95, 0
  s_mov_b64 exec, -1
L_nomask1:
  s_waitcnt lgkmcnt(4)
  v_mfma_f32_16x16x32_bf16 v[72:75], v[140:143], v[104:107], v[72:75]
  ds_read_b64_tr_b16 v[152:153], v32 offset:15376
  v_add_f32 v176, v68, v80
  v_add_f32 v177, v69, v81
  v_add_f32 v178, v70, v82
  v_add_f32 v179, v71, v83
  v_mul_f32 v180, v68, v68
  v_mfma_f32_16x16x32_bf16 v[84:87], v[140:143], v[108:111], v[84:87]
  ds_read_b64_tr_b16 v[154:155], v32 offset:16144
  v_mul_f32 v181, v69, v69
  v_mul_f32 v182, v70, v70
  v_mul_f32 v183, v71, v71
  v_fmac_f32 v180, v80, v80
  v_fmac_f32 v181, v81, v81
  v_mfma_f32_16x16x32_bf16 v[96:99], v[140:143], v[112:115], v[96:99]
  v_fmac_f32 v182, v82, v82
  v_fmac_f32 v183, v83, v83
  v_add_f32 v176, v176, v92
  v_add_f32 v177, v177, v93
  v_add_f32 v178, v178, v94
  s_waitcnt lgkmcnt(4)
  v_mfma_f32_16x16x32_bf16 v[72:75], v[144:147], v[108:111], v[72:75]
  ds_read_b64_tr_b16 v[156:157], v32 offset:18448
  v_add_f32 v179, v179, v95
  v_fmac_f32 v180, v92, v92
  v_fmac_f32 v181, v93, v93
  v_fmac_f32 v182, v94, v94
  v_fmac_f32 v183, v95, v95
  v_mfma_f32_16x16x32_bf16 v[84:87], v[144:147], v[112:115], v[84:87]
  ds_read_b64_tr_b16 v[158:159], v32 offset:19216
  v_add_f32_dpp v184, v176, v176 row_ror:8 row_mask:0xf bank_mask:0xf
  v_add_f32_dpp v185, v177, v177 row_ror:8 row_mask:0xf bank_mask:0xf
  v_add_f32_dpp v186, v180, v180 row_ror:8 row_mask:0xf bank_mask:0xf
  v_add_f32_dpp v187, v181, v181 row_ror:8 row_mask:0xf bank_mask:0xf
  v_add_f32_dpp v184, v178, v178 row_ror:8 row_mask:0xf bank_mask:0xc
  v_mfma_f32_16x16x32_bf16 v[96:99], v[144:147], v[116:119], v[96:99]
  v_add_f32_dpp v185, v179, v179 row_ror:8 row_mask:0xf bank_mask:0xc
  v_add_f32_dpp v186, v182, v182 row_ror:8 row_mask:0xf bank_mask:0xc
  v_add_f32_dpp v187, v183, v183 row_ror:8 row_mask:0xf bank_mask:0xc
  v_add_f32_dpp v176, v184, v184 row_half_mirror row_mask:0xf bank_mask:0xf
  v_add_f32_dpp v180, v186, v186 row_half_mirror row_mask:0xf bank_mask:0xf
  s_waitcnt lgkmcnt(4)
  v_mfma_f32_16x16x32_bf16 v[72:75], v[148:151], v[112:115], v[72:75]
  ds_read_b64_tr_b16 v[160:161], v32 offset:21520
  s_nop 0
  v_add_f32_dpp v176, v185, v185 row_half_mirror row_mask:0xf bank_mask:0xa
  v_add_f32_dpp v180, v187, v187 row_half_mirror row_mask:0xf bank_mask:0xa
  s_nop 0
  v_mfma_f32_16x16x32_bf16 v[84:87], v[148:151], v[116:119], v[84:87]
  ds_read_b64_tr_b16 v[162:163], v32 offset:22288
  v_add_f32_dpp v177, v176, v176 quad_perm:[1,0,3,2] row_mask:0xf bank_mask:0xf
  v_add_f32_dpp v181, v180, v180 quad_perm:[1,0,3,2] row_mask:0xf bank_mask:0xf
  s_nop 0
  v_add_f32_dpp v176, v177, v177 quad_perm:[2,3,0,1] row_mask:0xf bank_mask:0xf
  v_mfma_f32_16x16x32_bf16 v[96:99], v[148:151], v[120:123], v[96:99]
  v_add_f32_dpp v180, v181, v181 quad_perm:[2,3,0,1] row_mask:0xf bank_mask:0xf
  ds_write_b32 v33, v176 offset:128
  ds_write_b32 v33, v180 offset:144
  ds_write_b32 v34, v35 offset:16
  s_waitcnt lgkmcnt(7)
  v_mfma_f32_16x16x32_bf16 v[72:75], v[152:155], v[116:119], v[72:75]
  v_mfma_f32_16x16x32_bf16 v[84:87], v[152:155], v[120:123], v[84:87]
  v_mfma_f32_16x16x32_bf16 v[96:99], v[152:155], v[124:127], v[96:99]
  s_waitcnt lgkmcnt(5)
  v_mfma_f32_16x16x32_bf16 v[72:75], v[156:159], v[120:123], v[72:75]
  v_mfma_f32_16x16x32_bf16 v[84:87], v[156:159], v[124:127], v[84:87]
  v_mfma_f32_16x16x32_bf16 v[96:99], v[156:159], v[128:131], v[96:99]
  s_waitcnt lgkmcnt(3)
  v_mfma_f32_16x16x32_bf16 v[72:75], v[160:163], v[124:127], v[72:75]
  v_mfma_f32_16x16x32_bf16 v[84:87], v[160:163], v[128:131], v[84:87]
  v_mfma_f32_16x16x32_bf16 v[96:99], v[160:163], v[132:135], v[96:99]
  s_nop 6
  s_cmp_lg_u32 s24, 41
  s_cbranch_scc1 L_nomask2
  s_mov_b64 exec, s[40:41]
  v_mov_b32 v72, 0
  v_mov_b32 v73, 0
  v_mov_b32 v74, 0
  v_mov_b32 v75, 0
  s_mov_b64 exec, s[42:43]
  v_mov_b32 v84, 0
  v_mov_b32 v85, 0
  v_mov_b32 v86, 0
  v_mov_b32 v87, 0
  s_mov_b64 exec, s[44:45]
  v_mov_b32 v96, 0
  v_mov_b32 v97, 0
  v_mov_b32 v98, 0
  v_mov_b32 v99, 0
  s_mov_b64 exec, -1
L_nomask2:
  v_pk_add_f32 v[176:177], v[72:73], v[84:85]
  v_pk_mul_f32 v[180:181], v[72:73], v[72:73]
  v_pk_add_f32 v[178:179], v[74:75], v[86:87]
  v_pk_mul_f32 v[182:183], v[74:75], v[74:75]
  v_pk_add_f32 v[176:177], v[176:177], v[96:97]
  v_pk_fma_f32 v[180:181], v[84:85], v[84:85], v[180:181]
  v_pk_add_f32 v[178:179], v[178:179], v[98:99]
  v_pk_fma_f32 v[182:183], v[86:87], v[86:87], v[182:183]
  v_pk_fma_f32 v[180:181], v[96:97], v[96:97], v[180:181]
  v_pk_fma_f32 v[182:183], v[98:99], v[98:99], v[182:183]
  v_add_f32_dpp v184, v176, v176 row_ror:8 row_mask:0xf bank_mask:0xf
  v_add_f32_dpp v185, v177, v177 row_ror:8 row_mask:0xf bank_mask:0xf
  v_add_f32_dpp v186, v180, v180 row_ror:8 row_mask:0xf bank_mask:0xf
  v_add_f32_dpp v187, v181, v181 row_ror:8 row_mask:0xf bank_mask:0xf
  v_add_f32_dpp v184, v178, v178 row_ror:8 row_mask:0xf bank_mask:0xc
  v_add_f32_dpp v185, v179, v179 row_ror:8 row_mask:0xf bank_mask:0xc
  v_add_f32_dpp v186, v182, v182 row_ror:8 row_mask:0xf bank_mask:0xc
  v_add_f32_dpp v187, v183, v183 row_ror:8 row_mask:0xf bank_mask:0xc
  v_add_f32_dpp v176, v184, v184 row_half_mirror row_mask:0xf bank_mask:0xf
  v_add_f32_dpp v180, v186, v186 row_half_mirror row_mask:0xf bank_mask:0xf
  s_nop 0
  v_add_f32_dpp v176, v185, v185 row_half_mirror row_mask:0xf bank_mask:0xa
  v_add_f32_dpp v180, v187, v187 row_half_mirror row_mask:0xf bank_mask:0xa
  s_nop 0
  v_add_f32_dpp v177, v176, v176 quad_perm:[1,0,3,2] row_mask:0xf bank_mask:0xf
  v_add_f32_dpp v181, v180, v180 quad_perm:[1,0,3,2] row_mask:0xf bank_mask:0xf
  s_nop 0
  v_add_f32_dpp v176, v177, v177 quad_perm:[2,3,0,1] row_mask:0xf bank_mask:0xf
  v_add_f32_dpp v180, v181, v181 quad_perm:[2,3,0,1] row_mask:0xf bank_mask:0xf
  ds_write_b32 v33, v176 offset:256
  ds_write_b32 v33, v180 offset:272
  ds_write_b32 v34, v35 offset:32
  s_mov_b32 s39, 0x20000
  s_mov_b32 s38, 2301984
  s_mul_i32 s64, s23, 2301984
  s_add_u32 s36, s12, s64
  s_addc_u32 s37, s13, 0
  v_lshlrev_b32 v34, 5, v5
  v_add_u32 v34, 162816, v34
  v_mov_b32 v33, 163248
  v_mul_u32_u24 v35, 112, v6
  v_mul_u32_u24 v7, 24, v5
  v_add_u32 v35, v35, v7
  s_mul_i32 s62, s20, 5376
  s_mul_i32 s68, s24, 192
  s_mul_i32 s69, s20, 48
  s_add_u32 s68, s68, s69
  s_mul_i32 s68, s68, 288
  s_add_u32 s68, s68, s26
  v_mov_b32 v46, 0xc0135761
  v_mov_b32 v47, 0xc0135761
  v_mov_b32 v48, 0xbdd2d3e8
  v_mov_b32 v49, 0xbdd2d3e8
  v_mov_b32 v50, 1.0
  v_mov_b32 v51, 1.0
  v_mul_u32_u24 v8, 43, v1
  v_lshrrev_b32 v8, 8, v8
  v_mul_u32_u24 v9, 6, v8
  v_sub_u32 v9, v1, v9
  v_lshlrev_b32 v9, 4, v9
  v_mul_u32_u24 v10, 112, v8
  v_add3_u32 v36, v10, v9, s62
  v_mul_u32_u24 v10, 288, v8
  v_add3_u32 v41, v10, v9, s68
  v_cmp_gt_u32 vcc, 32, v9
  v_mov_b32 v7, 1200
  v_mov_b32 v8, 1184
  v_cndmask_b32 v7, v7, v8, vcc
  v_add_u32 v37, v36, v7
  v_mov_b32 v7, 3136
  v_mov_b32 v8, 2944
  v_cndmask_b32 v7, v7, v8, vcc
  v_add_u32 v42, v41, v7
  v_cmp_gt_u32 vcc, 64, v9
  v_mov_b32 v7, 2400
  v_mov_b32 v8, 2384
  v_cndmask_b32 v7, v7, v8, vcc
  v_add_u32 v38, v36, v7
  v_mov_b32 v7, 6272
  v_mov_b32 v8, 6080
  v_cndmask_b32 v7, v7, v8, vcc
  v_add_u32 v43, v41, v7
  v_add_u32 v44, 9216, v41
  v_add_u32 v45, 9216, v42
  s_branch L_cx0
L_cw0:
  s_sleep 1
L_cx0:
  ds_read_b32 v7, v33 offset:0
  ds_read_b128 v[100:103], v34 offset:0
  ds_read_b128 v[104:107], v34 offset:16
  s_waitcnt lgkmcnt(0)
  v_readfirstlane_b32 s62, v7
  s_cmp_eq_u32 s62, 0
  s_cbranch_scc1 L_cw0
L_cy0:
  v_pk_fma_f32 v[64:65], v[64:65], v[100:101], v[104:105]
  v_pk_fma_f32 v[66:67], v[66:67], v[102:103], v[106:107]
  v_pk_fma_f32 v[76:77], v[76:77], v[100:101], v[104:105]
  v_pk_fma_f32 v[78:79], v[78:79], v[102:103], v[106:107]
  v_pk_fma_f32 v[88:89], v[88:89], v[100:101], v[104:105]
  v_pk_fma_f32 v[90:91], v[90:91], v[102:103], v[106:107]
  v_pk_mul_f32 v[140:141], v[64:65], v[64:65]
  v_pk_mul_f32 v[142:143], v[66:67], v[66:67]
  v_pk_mul_f32 v[144:145], v[76:77], v[76:77]
  v_pk_mul_f32 v[146:147], v[78:79], v[78:79]
  v_pk_mul_f32 v[148:149], v[88:89], v[88:89]
  v_pk_mul_f32 v[150:151], v[90:91], v[90:91]
  v_pk_fma_f32 v[140:141], v[140:141], v[48:49], v[46:47]
  v_pk_fma_f32 v[142:143], v[142:143], v[48:49], v[46:47]
  v_pk_fma_f32 v[144:145], v[144:145], v[48:49], v[46:47]
  v_pk_fma_f32 v[146:147], v[146:147], v[48:49], v[46:47]
  v_pk_fma_f32 v[148:149], v[148:149], v[48:49], v[46:47]
  v_pk_fma_f32 v[150:151], v[150:151], v[48:49], v[46:47]
  v_pk_mul_f32 v[140:141], v[140:141], v[64:65]
  v_pk_mul_f32 v[142:143], v[142:143], v[66:67]
  v_pk_mul_f32 v[144:145], v[144:145], v[76:77]
  v_pk_mul_f32 v[146:147], v[146:147], v[78:79]
  v_pk_mul_f32 v[148:149], v[148:149], v[88:89]
  v_pk_mul_f32 v[150:151], v[150:151], v[90:91]
  v_exp_f32 v140, v140
  v_exp_f32 v141, v141
  v_exp_f32 v142, v142
  v_exp_f32 v143, v143
  v_exp_f32 v144, v144
  v_exp_f32 v145, v145
  v_exp_f32 v146, v146
  v_exp_f32 v147, v147
  v_exp_f32 v148, v148
  v_exp_f32 v149, v149
  v_exp_f32 v150, v150
  v_exp_f32 v151, v151
  v_pk_add_f32 v[140:141], v[140:141], v[50:51]
  v_pk_add_f32 v[142:143], v[142:143], v[50:51]
  v_pk_add_f32 v[144:145], v[144:145], v[50:51]
  v_pk_add_f32 v[146:147], v[146:147], v[50:51]
  v_pk_add_f32 v[148:149], v[148:149], v[50:51]
  v_pk_add_f32 v[150:151], v[150:151], v[50:51]
  v_rcp_f32 v140, v140
  v_rcp_f32 v141, v141
  v_rcp_f32 v142, v142
  v_rcp_f32 v143, v143
  v_rcp_f32 v144, v144
  v_rcp_f32 v145, v145
  v_rcp_f32 v146, v146
  v_rcp_f32 v147, v147
  v_rcp_f32 v148, v148
  v_rcp_f32 v149, v149
  v_rcp_f32 v150, v150
  v_rcp_f32 v151, v151
  v_pk_mul_f32 v[140:141], v[140:141], v[64:65]
  v_pk_mul_f32 v[142:143], v[142:143], v[66:67]
  v_pk_mul_f32 v[144:145], v[144:145], v[76:77]
  v_pk_mul_f32 v[146:147], v[146:147], v[78:79]
  v_pk_mul_f32 v[148:149], v[148:149], v[88:89]
  v_pk_mul_f32 v[150:151], v[150:151], v[90:91]
  ds_read_b32 v8, v33 offset:4
  ds_read_b128 v[108:111], v34 offset:128
  ds_read_b128 v[112:115], v34 offset:144
  v_cvt_pk_bf16_f32 v152, v140, v141
  v_cvt_pk_bf16_f32 v153, v142, v143
  v_cvt_pk_bf16_f32 v154, v144, v145
  v_cvt_pk_bf16_f32 v155, v146, v147
  v_cvt_pk_bf16_f32 v156, v148, v149
  v_cvt_pk_bf16_f32 v157, v150, v151
  ds_write_b64 v35, v[152:153] offset:0
  ds_write_b64 v35, v[154:155] offset:112
  ds_write_b64 v35, v[156:157] offset:224
  s_waitcnt lgkmcnt(3)
  v_readfirstlane_b32 s62, v8
  s_cmp_lg_u32 s62, 0
  s_cbranch_scc1 L_cy1
L_cw1:
  s_sleep 1
L_cx1:
  ds_read_b32 v8, v33 offset:4
  ds_read_b128 v[108:111], v34 offset:128
  ds_read_b128 v[112:115], v34 offset:144
  s_waitcnt lgkmcnt(0)
  v_readfirstlane_b32 s62, v8
  s_cmp_eq_u32 s62, 0
  s_cbranch_scc1 L_cw1
L_cy1:
  v_pk_fma_f32 v[68:69], v[68:69], v[108:109], v[112:113]
  v_pk_fma_f32 v[70:71], v[70:71], v[110:111], v[114:115]
  v_pk_fma_f32 v[80:81], v[80:81], v[108:109], v[112:113]
  v_pk_fma_f32 v[82:83], v[82:83], v[110:111], v[114:115]
  v_pk_fma_f32 v[92:93], v[92:93], v[108:109], v[112:113]
  v_pk_fma_f32 v[94:95], v[94:95], v[110:111], v[114:115]
  v_pk_mul_f32 v[140:141], v[68:69], v[68:69]
  v_pk_mul_f32 v[142:143], v[70:71], v[70:71]
  v_pk_mul_f32 v[144:145], v[80:81], v[80:81]
  v_pk_mul_f32 v[146:147], v[82:83], v[82:83]
  v_pk_mul_f32 v[148:149], v[92:93], v[92:93]
  v_pk_mul_f32 v[150:151], v[94:95], v[94:95]
  v_pk_fma_f32 v[140:141], v[140:141], v[48:49], v[46:47]
  v_pk_fma_f32 v[142:143], v[142:143], v[48:49], v[46:47]
  v_pk_fma_f32 v[144:145], v[144:145], v[48:49], v[46:47]
  v_pk_fma_f32 v[146:147], v[146:147], v[48:49], v[46:47]
  v_pk_fma_f32 v[148:149], v[148:149], v[48:49], v[46:47]
  v_pk_fma_f32 v[150:151], v[150:151], v[48:49], v[46:47]
  v_pk_mul_f32 v[140:141], v[140:141], v[68:69]
  v_pk_mul_f32 v[142:143], v[142:143], v[70:71]
  v_pk_mul_f32 v[144:145], v[144:145], v[80:81]
  v_pk_mul_f32 v[146:147], v[146:147], v[82:83]
  v_pk_mul_f32 v[148:149], v[148:149], v[92:93]
  v_pk_mul_f32 v[150:151], v[150:151], v[94:95]
  v_exp_f32 v140, v140
  v_exp_f32 v141, v141
  v_exp_f32 v142, v142
  v_exp_f32 v143, v143
  v_exp_f32 v144, v144
  v_exp_f32 v145, v145
  v_exp_f32 v146, v146
  v_exp_f32 v147, v147
  v_exp_f32 v148, v148
  v_exp_f32 v149, v149
  v_exp_f32 v150, v150
  v_exp_f32 v151, v151
  v_pk_add_f32 v[140:141], v[140:141], v[50:51]
  v_pk_add_f32 v[142:143], v[142:143], v[50:51]
  v_pk_add_f32 v[144:145], v[144:145], v[50:51]
  v_pk_add_f32 v[146:147], v[146:147], v[50:51]
  v_pk_add_f32 v[148:149], v[148:149], v[50:51]
  v_pk_add_f32 v[150:151], v[150:151], v[50:51]
  v_rcp_f32 v140, v140
  v_rcp_f32 v141, v141
  v_rcp_f32 v142, v142
  v_rcp_f32 v143, v143
  v_rcp_f32 v144, v144
  v_rcp_f32 v145, v145
  v_rcp_f32 v146, v146
  v_rcp_f32 v147, v147
  v_rcp_f32 v148, v148
  v_rcp_f32 v149, v149
  v_rcp_f32 v150, v150
  v_rcp_f32 v151, v151
  v_pk_mul_f32 v[140:141], v[140:141], v[68:69]
  v_pk_mul_f32 v[142:143], v[142:143], v[70:71]
  v_pk_mul_f32 v[144:145], v[144:145], v[80:81]
  v_pk_mul_f32 v[146:147], v[146:147], v[82:83]
  v_pk_mul_f32 v[148:149], v[148:149], v[92:93]
  v_pk_mul_f32 v[150:151], v[150:151], v[94:95]
  ds_read_b32 v9, v33 offset:8
  ds_read_b128 v[116:119], v34 offset:256
  ds_read_b128 v[120:123], v34 offset:272
  v_cvt_pk_bf16_f32 v158, v140, v141
  v_cvt_pk_bf16_f32 v159, v142, v143
  v_cvt_pk_bf16_f32 v160, v144, v145
  v_cvt_pk_bf16_f32 v161, v146, v147
  v_cvt_pk_bf16_f32 v162, v148, v149
  v_cvt_pk_bf16_f32 v163, v150, v151
  ds_write_b64 v35, v[158:159] offset:8
  ds_write_b64 v35, v[160:161] offset:120
  ds_write_b64 v35, v[162:163] offset:232
  s_waitcnt lgkmcnt(3)
  v_readfirstlane_b32 s62, v9
  s_cmp_lg_u32 s62, 0
  s_cbranch_scc1 L_cy2
L_cw2:
  s_sleep 1
L_cx2:
  ds_read_b32 v9, v33 offset:8
  ds_read_b128 v[116:119], v34 offset:256
  ds_read_b128 v[120:123], v34 offset:272
  s_waitcnt lgkmcnt(0)
  v_readfirstlane_b32 s62, v9
  s_cmp_eq_u32 s62, 0
  s_cbranch_scc1 L_cw2
L_cy2:
  v_pk_fma_f32 v[72:73], v[72:73], v[116:117], v[120:121]
  v_pk_fma_f32 v[74:75], v[74:75], v[118:119], v[122:123]
  v_pk_fma_f32 v[84:85], v[84:85], v[116:117], v[120:121]
  v_pk_fma_f32 v[86:87], v[86:87], v[118:119], v[122:123]
  v_pk_fma_f32 v[96:97], v[96:97], v[116:117], v[120:121]
  v_pk_fma_f32 v[98:99], v[98:99], v[118:119], v[122:123]
  v_pk_mul_f32 v[140:141], v[72:73], v[72:73]
  v_pk_mul_f32 v[142:143], v[74:75], v[74:75]
  v_pk_mul_f32 v[144:145], v[84:85], v[84:85]
  v_pk_mul_f32 v[146:147], v[86:87], v[86:87]
  v_pk_mul_f32 v[148:149], v[96:97], v[96:97]
  v_pk_mul_f32 v[150:151], v[98:99], v[98:99]
  v_pk_fma_f32 v[140:141], v[140:141], v[48:49], v[46:47]
  v_pk_fma_f32 v[142:143], v[142:143], v[48:49], v[46:47]
  v_pk_fma_f32 v[144:145], v[144:145], v[48:49], v[46:47]
  v_pk_fma_f32 v[146:147], v[146:147], v[48:49], v[46:47]
  v_pk_fma_f32 v[148:149], v[148:149], v[48:49], v[46:47]
  v_pk_fma_f32 v[150:151], v[150:151], v[48:49], v[46:47]
  v_pk_mul_f32 v[140:141], v[140:141], v[72:73]
  v_pk_mul_f32 v[142:143], v[142:143], v[74:75]
  v_pk_mul_f32 v[144:145], v[144:145], v[84:85]
  v_pk_mul_f32 v[146:147], v[146:147], v[86:87]
  v_pk_mul_f32 v[148:149], v[148:149], v[96:97]
  v_pk_mul_f32 v[150:151], v[150:151], v[98:99]
  v_exp_f32 v140, v140
  v_exp_f32 v141, v141
  v_exp_f32 v142, v142
  v_exp_f32 v143, v143
  v_exp_f32 v144, v144
  v_exp_f32 v145, v145
  v_exp_f32 v146, v146
  v_exp_f32 v147, v147
  v_exp_f32 v148, v148
  v_exp_f32 v149, v149
  v_exp_f32 v150, v150
  v_exp_f32 v151, v151
  v_pk_add_f32 v[140:141], v[140:141], v[50:51]
  v_pk_add_f32 v[142:143], v[142:143], v[50:51]
  v_pk_add_f32 v[144:145], v[144:145], v[50:51]
  v_pk_add_f32 v[146:147], v[146:147], v[50:51]
  v_pk_add_f32 v[148:149], v[148:149], v[50:51]
  v_pk_add_f32 v[150:151], v[150:151], v[50:51]
  v_rcp_f32 v140, v140
  v_rcp_f32 v141, v141
  v_rcp_f32 v142, v142
  v_rcp_f32 v143, v143
  v_rcp_f32 v144, v144
  v_rcp_f32 v145, v145
  v_rcp_f32 v146, v146
  v_rcp_f32 v147, v147
  v_rcp_f32 v148, v148
  v_rcp_f32 v149, v149
  v_rcp_f32 v150, v150
  v_rcp_f32 v151, v151
  v_pk_mul_f32 v[140:141], v[140:141], v[72:73]
  v_pk_mul_f32 v[142:143], v[142:143], v[74:75]
  v_pk_mul_f32 v[144:145], v[144:145], v[84:85]
  v_pk_mul_f32 v[146:147], v[146:147], v[86:87]
  v_pk_mul_f32 v[148:149], v[148:149], v[96:97]
  v_pk_mul_f32 v[150:151], v[150:151], v[98:99]
  v_cvt_pk_bf16_f32 v152, v140, v141
  v_cvt_pk_bf16_f32 v153, v142, v143
  v_cvt_pk_bf16_f32 v154, v144, v145
  v_cvt_pk_bf16_f32 v155, v146, v147
  v_cvt_pk_bf16_f32 v156, v148, v149
  v_cvt_pk_bf16_f32 v157, v150, v151
  ds_write_b64 v35, v[152:153] offset:16
  ds_write_b64 v35, v[154:155] offset:128
  ds_write_b64 v35, v[156:157] offset:240
  s_waitcnt lgkmcnt(0)
  ds_read_b128 v[64:67], v36 offset:0
  ds_read_b128 v[68:71], v37 offset:0
  ds_read_b128 v[72:75], v38 offset:0
  ds_read_b128 v[76:79], v36 offset:3584
  ds_read_b128 v[80:83], v37 offset:3584
  s_waitcnt lgkmcnt(4)
  buffer_store_dwordx4 v[64:67], v41, s[36:39], 0 offen
  s_waitcnt lgkmcnt(3)
  buffer_store_dwordx4 v[68:71], v42, s[36:39], 0 offen
  s_waitcnt lgkmcnt(2)
  buffer_store_dwordx4 v[72:75], v43, s[36:39], 0 offen
  s_waitcnt lgkmcnt(1)
  buffer_store_dwordx4 v[76:79], v44, s[36:39], 0 offen
  s_waitcnt lgkmcnt(0)
  s_mov_b64 exec, s[56:57]
  buffer_store_dwordx4 v[80:83], v45, s[36:39], 0 offen
  s_endpgm
.p2align 12
L_x4:
  s_mov_b32 s43, 0x20000
  s_mov_b32 s47, 0x20000
  s_mov_b32 s51, 0x20000
  s_mov_b32 s55, 0x20000
  s_mov_b32 s42, 16128
  s_mov_b32 s46, 256
  s_mov_b32 s50, 288
  s_mov_b32 s54, 288
  s_mul_i32 s65, s25, 16128
  s_add_u32 s40, s16, s65
  s_addc_u32 s41, s17, 0
  s_mov_b32 s44, s14
  s_mov_b32 s45, s15
  s_mov_b32 s48, s8
  s_mov_b32 s49, s9
  s_mov_b32 s52, s10
  s_mov_b32 s53, s11
  v_mul_u32_u24 v8, 31, v1
  v_add_u32 v8, s61, v8
  s_lshr_b32 s63, s60, 2
  s_add_u32 s62, s63, 5
  v_lshrrev_b32 v21, s62, v8
  v_lshlrev_b32 v9, s62, v21
  v_sub_u32 v8, v8, v9
  v_lshrrev_b32 v9, 3, v8
  v_and_b32 v8, 7, v8
  v_lshrrev_b32 v10, s63, v9
  v_mul_u32_u24 v10, 3, v10
  v_and_b32 v9, s63, v9
  v_add_u32 v10, v10, v9
  s_xor_b32 s63, s63, 1
  s_lshl_b32 s63, s63, 1
  v_add_u32 v10, s63, v10
  v_lshl_add_u32 v8, v10, 3, v8
  v_mul_u32_u24 v22, 1152, v8
  v_add_u32 v22, s21, v22
  v_cmp_gt_u32 vcc, 3, v21
  v_mov_b32 v8, 9216000
  v_lshlrev_b32 v21, 2, v21
  v_cndmask_b32 v22, v8, v22, vcc
  s_waitcnt vmcnt(2)
  s_barrier
  s_add_u32 m0, s19, 64000
  s_mov_b32 s62, 640
  buffer_load_dwordx4 v14, s[28:31], s62 offen lds
  s_add_u32 m0, s19, 67072
  s_mov_b32 s62, 28288
  buffer_load_dwordx4 v14, s[28:31], s62 offen lds
  s_add_u32 m0, s19, 70144
  s_mov_b32 s62, 55936
  buffer_load_dwordx4 v14, s[28:31], s62 offen lds
  s_add_u32 m0, s19, 73216
  s_mov_b32 s62, 83584
  buffer_load_dwordx4 v14, s[28:31], s62 offen lds
  s_waitcnt vmcnt(5)
  s_barrier
  s_add_u32 m0, s18, 12800
  s_mov_b32 s62, 128
  buffer_load_dwordx4 v3, s[28:31], s62 offen lds
  s_add_u32 m0, s18, 18944
  s_mov_b32 s62, 55424
  buffer_load_dwordx4 v3, s[28:31], s62 offen lds
  s_mov_b32 m0, 25088
  s_mov_b32 s62, 110720
  s_mov_b64 exec, s[56:57]
  buffer_load_dwordx4 v2, s[28:31], s62 offen lds
  s_mov_b64 exec, -1
  s_add_u32 m0, s18, 79872
  s_mov_b32 s62, 28416
  buffer_load_dwordx4 v3, s[28:31], s62 offen lds
  s_add_u32 m0, s18, 86016
  s_mov_b32 s62, 83712
  buffer_load_dwordx4 v3, s[28:31], s62 offen lds
  s_add_u32 m0, s18, 25600
  s_mov_b32 s62, 256
  buffer_load_dwordx4 v3, s[28:31], s62 offen lds
  s_add_u32 m0, s18, 31744
  s_mov_b32 s62, 55552
  buffer_load_dwordx4 v3, s[28:31], s62 offen lds
  s_mov_b32 m0, 37888
  s_mov_b32 s62, 110848
  s_mov_b64 exec, s[56:57]
  buffer_load_dwordx4 v2, s[28:31], s62 offen lds
  s_mov_b64 exec, -1
  s_movk_i32 s62, 609
  v_bfe_u32 v8, s62, v21, 4
  v_lshl_add_u32 v8, v8, 7, v22
  s_mov_b64 exec, 0x7f
  buffer_load_dword v188, v8, s[36:39], 0 offen
  s_mov_b64 exec, -1
  s_waitcnt vmcnt(13)
  s_barrier
  s_barrier
  s_waitcnt vmcnt(9)
  s_barrier
  s_barrier
  s_add_u32 m0, s19, 12800
  s_mov_b32 s62, 128
  buffer_load_dwordx4 v14, s[28:31], s62 offen lds
  s_add_u32 m0, s19, 15872
  s_mov_b32 s62, 27776
  buffer_load_dwordx4 v14, s[28:31], s62 offen lds
  s_add_u32 m0, s19, 18944
  s_mov_b32 s62, 55424
  buffer_load_dwordx4 v14, s[28:31], s62 offen lds
  s_add_u32 m0, s19, 22016
  s_mov_b32 s62, 83072
  buffer_load_dwordx4 v14, s[28:31], s62 offen lds
  s_barrier
  s_sleep 3
  s_add_u32 m0, s19, 76800
  s_mov_b32 s62, 768
  buffer_load_dwordx4 v14, s[28:31], s62 offen lds
  s_add_u32 m0, s19, 79872
  s_mov_b32 s62, 28416
  buffer_load_dwordx4 v14, s[28:31], s62 offen lds
  s_add_u32 m0, s19, 82944
  s_mov_b32 s62, 56064
  buffer_load_dwordx4 v14, s[28:31], s62 offen lds
  s_add_u32 m0, s19, 86016
  s_mov_b32 s62, 83712
  buffer_load_dwordx4 v14, s[28:31], s62 offen lds
  s_waitcnt vmcnt(4)
  s_barrier
  s_barrier
  s_add_u32 m0, s19, 25600
  s_mov_b32 s62, 256
  buffer_load_dwordx4 v14, s[28:31], s62 offen lds
  s_add_u32 m0, s19, 28672
  s_mov_b32 s62, 27904
  buffer_load_dwordx4 v14, s[28:31], s62 offen lds
  s_add_u32 m0, s19, 31744
  s_mov_b32 s62, 55552
  buffer_load_dwordx4 v14, s[28:31], s62 offen lds
  s_add_u32 m0, s19, 34816
  s_mov_b32 s62, 83200
  buffer_load_dwordx4 v14, s[28:31], s62 offen lds
  s_waitcnt vmcnt(4)
  s_barrier
  s_sleep 3
  s_add_u32 m0, s18, 89600
  s_mov_b32 s62, 896
  buffer_load_dwordx4 v3, s[28:31], s62 offen lds
  s_add_u32 m0, s18, 95744
  s_mov_b32 s62, 56192
  buffer_load_dwordx4 v3, s[28:31], s62 offen lds
  s_mov_b32 m0, 101888
  s_mov_b32 s62, 111488
  s_mov_b64 exec, s[56:57]
  buffer_load_dwordx4 v2, s[28:31], s62 offen lds
  s_mov_b64 exec, -1
  s_add_u32 m0, s18, 41472
  s_mov_b32 s62, 28032
  buffer_load_dwordx4 v3, s[28:31], s62 offen lds
  s_add_u32 m0, s18, 47616
  s_mov_b32 s62, 83328
  buffer_load_dwordx4 v3, s[28:31], s62 offen lds
  s_add_u32 m0, s18, 102400
  s_mov_b32 s62, 1024
  buffer_load_dwordx4 v3, s[28:31], s62 offen lds
  s_add_u32 m0, s18, 108544
  s_mov_b32 s62, 56320
  buffer_load_dwordx4 v3, s[28:31], s62 offen lds
  s_mov_b32 m0, 114688
  s_mov_b32 s62, 111616
  s_mov_b64 exec, s[56:57]
  buffer_load_dwordx4 v2, s[28:31], s62 offen lds
  s_mov_b64 exec, -1
  s_movk_i32 s62, 2103
  v_bfe_u32 v8, s62, v21, 4
  v_lshl_add_u32 v8, v8, 7, v22
  s_mov_b64 exec, 0x7f
  buffer_load_dword v188, v8, s[36:39], 0 offen
  s_mov_b64 exec, -1
  s_barrier
  s_barrier
  s_waitcnt vmcnt(9)
  s_barrier
  s_add_u32 m0, s19, 89600
  s_mov_b32 s62, 896
  buffer_load_dwordx4 v14, s[28:31], s62 offen lds
  s_add_u32 m0, s19, 92672
  s_mov_b32 s62, 28544
  buffer_load_dwordx4 v14, s[28:31], s62 offen lds
  s_add_u32 m0, s19, 95744
  s_mov_b32 s62, 56192
  buffer_load_dwordx4 v14, s[28:31], s62 offen lds
  s_add_u32 m0, s19, 98816
  s_mov_b32 s62, 83840
  buffer_load_dwordx4 v14, s[28:31], s62 offen lds
  s_barrier
  s_barrier
  s_add_u32 m0, s19, 38400
  s_mov_b32 s62, 384
  buffer_load_dwordx4 v14, s[28:31], s62 offen lds
  s_add_u32 m0, s19, 41472
  s_mov_b32 s62, 28032
  buffer_load_dwordx4 v14, s[28:31], s62 offen lds
  s_add_u32 m0, s19, 44544
  s_mov_b32 s62, 55680
  buffer_load_dwordx4 v14, s[28:31], s62 offen lds
  s_add_u32 m0, s19, 47616
  s_mov_b32 s62, 83328
  buffer_load_dwordx4 v14, s[28:31], s62 offen lds
  s_waitcnt vmcnt(4)
  s_barrier
  s_barrier
  s_add_u32 m0, s19, 102400
  s_mov_b32 s62, 1024
  buffer_load_dwordx4 v14, s[28:31], s62 offen lds
  s_add_u32 m0, s19, 105472
  s_mov_b32 s62, 28672
  buffer_load_dwordx4 v14, s[28:31], s62 offen lds
  s_add_u32 m0, s19, 108544
  s_mov_b32 s62, 56320
  buffer_load_dwordx4 v14, s[28:31], s62 offen lds
  s_add_u32 m0, s19, 111616
  s_mov_b32 s62, 83968
  buffer_load_dwordx4 v14, s[28:31], s62 offen lds
  s_waitcnt vmcnt(4)
  s_barrier
  s_barrier
  s_sub_u32 s58, s20, 4
  v_bfe_u32 v5, v1, 1, 2
  v_lshrrev_b32 v7, 4, v1
  v_mul_u32_u24 v6, 12, v5
  s_lshl_b32 s63, s58, 2
  v_add3_u32 v8, v6, v7, s63
  v_lshlrev_b32 v8, 1, v8
  v_add_u32 v52, s26, v8
  v_and_b32 v4, 7, v1
  v_lshlrev_b32 v4, 4, v4
  s_lshl_b32 s63, s58, 7
  v_lshl_add_u32 v42, v7, 2, v4
  s_add_u32 s64, s63, 162816
  v_add_u32 v42, s64, v42
  v_lshrrev_b32 v44, 3, v1
  v_mul_u32_u24 v44, 384, v44
  v_add3_u32 v44, v44, v4, s63
  s_mul_i32 s64, s24, 384
  s_add_u32 s64, s64, s63
  v_add_u32 v45, s64, v4
  s_add_u32 s64, s63, 161280
  v_add_u32 v46, s64, v4
  s_lshl_b32 s64, s58, 4
  s_add_u32 s64, s64, 163200
  v_mov_b32 v47, s64
  s_lshl_b32 s64, s58, 2
  s_add_u32 s64, s64, 163248
  v_mov_b32 v48, s64
  v_mov_b32 v49, 1
  v_mov_b32 v50, 0x39032fd1
  v_add_u32 v51, 16, v48
  v_and_b32 v4, 1, v1
  v_cmp_eq_u32 s[68:69], 1, v4
  s_waitcnt vmcnt(0)
  s_barrier
  buffer_load_ushort v40, v52, s[48:51], 0 offen
  buffer_load_ushort v41, v52, s[52:55], 0 offen
  s_barrier
  s_barrier
  s_barrier
  s_branch L_gather
L_x5:
  s_mov_b32 s43, 0x20000
  s_mov_b32 s47, 0x20000
  s_mov_b32 s51, 0x20000
  s_mov_b32 s55, 0x20000
  s_mov_b32 s42, 16128
  s_mov_b32 s46, 256
  s_mov_b32 s50, 288
  s_mov_b32 s54, 288
  s_mul_i32 s65, s25, 16128
  s_add_u32 s40, s16, s65
  s_addc_u32 s41, s17, 0
  s_mov_b32 s44, s14
  s_mov_b32 s45, s15
  s_mov_b32 s48, s8
  s_mov_b32 s49, s9
  s_mov_b32 s52, s10
  s_mov_b32 s53, s11
  v_mov_b32 v49, 1
  v_mov_b32 v24, -1
  v_mov_b32 v25, -1
  v_mov_b32 v26, -1
  v_mov_b32 v27, -1
  v_lshlrev_b32 v12, 4, v1
  s_mul_i32 s62, s24, 384
  v_add_u32 v12, s62, v12
  s_lshl_b32 s62, s22, 5
  s_lshl_b32 s63, s23, 7
  s_add_u32 s62, s62, s63
  v_mov_b32 v13, s62
  s_mul_i32 s59, s61, 205
  s_lshr_b32 s59, s59, 11
  s_mul_i32 s59, s59, 10
  s_sub_u32 s59, s61, s59
  s_add_u32 s59, s59, 7
  v_mul_u32_u24 v8, 31, v1
  v_add_u32 v8, s61, v8
  v_mul_u32_u24 v9, 911, v8
  v_lshrrev_b32 v9, 16, v9
  v_mul_u32_u24 v10, 72, v9
  v_sub_u32 v10, v8, v10
  v_lshlrev_b32 v10, 7, v10
  s_mov_b32 s62, 82944
  v_cmp_gt_u32 vcc, 19, v1
  v_mad_u32_u24 v20, v9, s62, v10
  s_nop 0
  v_cndmask_b32 v20, -1, v20, vcc
  s_waitcnt vmcnt(2)
  s_barrier
  s_add_u32 m0, s27, 64000
  s_mov_b32 s62, 640
  buffer_load_dwordx4 v15, s[28:31], s62 offen lds
  s_add_u32 m0, s27, 67072
  s_mov_b32 s62, 28288
  buffer_load_dwordx4 v15, s[28:31], s62 offen lds
  s_add_u32 m0, s27, 70144
  s_mov_b32 s62, 55936
  buffer_load_dwordx4 v15, s[28:31], s62 offen lds
  s_add_u32 m0, s27, 73216
  s_mov_b32 s62, 83584
  buffer_load_dwordx4 v15, s[28:31], s62 offen lds
  s_mov_b32 s62, 18432
  buffer_load_dword v188, v20, s[32:35], s62 offen offset:2048 sc1
  s_mov_b32 s62, 27648
  buffer_load_dword v188, v20, s[32:35], s62 offen offset:2048 sc1
  s_waitcnt vmcnt(7)
  s_barrier
  s_add_u32 m0, s18, 15872
  s_mov_b32 s62, 27776
  buffer_load_dwordx4 v3, s[28:31], s62 offen lds
  s_add_u32 m0, s18, 22016
  s_mov_b32 s62, 83072
  buffer_load_dwordx4 v3, s[28:31], s62 offen lds
  s_add_u32 m0, s18, 76800
  s_mov_b32 s62, 768
  buffer_load_dwordx4 v3, s[28:31], s62 offen lds
  s_add_u32 m0, s18, 82944
  s_mov_b32 s62, 56064
  buffer_load_dwordx4 v3, s[28:31], s62 offen lds
  s_mov_b32 m0, 89088
  s_mov_b32 s62, 111360
  s_mov_b64 exec, s[56:57]
  buffer_load_dwordx4 v2, s[28:31], s62 offen lds
  s_mov_b64 exec, -1
  s_add_u32 m0, s18, 28672
  s_mov_b32 s62, 27904
  buffer_load_dwordx4 v3, s[28:31], s62 offen lds
  s_add_u32 m0, s18, 34816
  s_mov_b32 s62, 83200
  buffer_load_dwordx4 v3, s[28:31], s62 offen lds
  s_mov_b32 s62, 36864
  buffer_load_dword v188, v20, s[32:35], s62 offen offset:2048 sc1
  s_waitcnt vmcnt(14)
  s_barrier
  s_mov_b64 exec, 0xffffff
  buffer_store_dwordx4 v[24:27], v12, s[40:43], 0 offen sc1
  s_mov_b64 exec, -1
  s_barrier
  s_waitcnt vmcnt(11)
  s_barrier
  s_barrier
  s_add_u32 m0, s27, 12800
  s_mov_b32 s62, 128
  buffer_load_dwordx4 v15, s[28:31], s62 offen lds
  s_add_u32 m0, s27, 15872
  s_mov_b32 s62, 27776
  buffer_load_dwordx4 v15, s[28:31], s62 offen lds
  s_add_u32 m0, s27, 18944
  s_mov_b32 s62, 55424
  buffer_load_dwordx4 v15, s[28:31], s62 offen lds
  s_add_u32 m0, s27, 22016
  s_mov_b32 s62, 83072
  buffer_load_dwordx4 v15, s[28:31], s62 offen lds
  s_barrier
  s_sleep 3
  s_add_u32 m0, s27, 76800
  s_mov_b32 s62, 768
  buffer_load_dwordx4 v15, s[28:31], s62 offen lds
  s_add_u32 m0, s27, 79872
  s_mov_b32 s62, 28416
  buffer_load_dwordx4 v15, s[28:31], s62 offen lds
  s_add_u32 m0, s27, 82944
  s_mov_b32 s62, 56064
  buffer_load_dwordx4 v15, s[28:31], s62 offen lds
  s_add_u32 m0, s27, 86016
  s_mov_b32 s62, 83712
  buffer_load_dwordx4 v15, s[28:31], s62 offen lds
  s_mov_b32 s62, 46080
  buffer_load_dword v188, v20, s[32:35], s62 offen offset:2048 sc1
  s_mov_b32 s62, 55296
  buffer_load_dword v188, v20, s[32:35], s62 offen offset:2048 sc1
  s_waitcnt vmcnt(6)
  s_barrier
  s_cmp_lg_u32 s59, 7
  s_cbranch_scc1 L_nc7
  s_mov_b64 exec, 1
  buffer_atomic_add v49, v13, s[44:47], 0 offen
  s_mov_b64 exec, -1
L_nc7:
  s_barrier
  s_add_u32 m0, s27, 25600
  s_mov_b32 s62, 256
  buffer_load_dwordx4 v15, s[28:31], s62 offen lds
  s_add_u32 m0, s27, 28672
  s_mov_b32 s62, 27904
  buffer_load_dwordx4 v15, s[28:31], s62 offen lds
  s_add_u32 m0, s27, 31744
  s_mov_b32 s62, 55552
  buffer_load_dwordx4 v15, s[28:31], s62 offen lds
  s_add_u32 m0, s27, 34816
  s_mov_b32 s62, 83200
  buffer_load_dwordx4 v15, s[28:31], s62 offen lds
  s_cmp_lg_u32 s59, 8
  s_cbranch_scc1 L_nc8
  s_mov_b64 exec, 1
  buffer_atomic_add v49, v13, s[44:47], 0 offen
  s_mov_b64 exec, -1
L_nc8:
  s_waitcnt vmcnt(6)
  s_barrier
  s_sleep 3
  s_add_u32 m0, s18, 92672
  s_mov_b32 s62, 28544
  buffer_load_dwordx4 v3, s[28:31], s62 offen lds
  s_add_u32 m0, s18, 98816
  s_mov_b32 s62, 83840
  buffer_load_dwordx4 v3, s[28:31], s62 offen lds
  s_add_u32 m0, s18, 38400
  s_mov_b32 s62, 384
  buffer_load_dwordx4 v3, s[28:31], s62 offen lds
  s_add_u32 m0, s18, 44544
  s_mov_b32 s62, 55680
  buffer_load_dwordx4 v3, s[28:31], s62 offen lds
  s_mov_b32 m0, 50688
  s_mov_b32 s62, 110976
  s_mov_b64 exec, s[56:57]
  buffer_load_dwordx4 v2, s[28:31], s62 offen lds
  s_mov_b64 exec, -1
  s_add_u32 m0, s18, 105472
  s_mov_b32 s62, 28672
  buffer_load_dwordx4 v3, s[28:31], s62 offen lds
  s_add_u32 m0, s18, 111616
  s_mov_b32 s62, 83968
  buffer_load_dwordx4 v3, s[28:31], s62 offen lds
  s_mov_b32 s62, 64512
  buffer_load_dword v188, v20, s[32:35], s62 offen offset:2048 sc1
  s_mov_b32 s62, 73728
  buffer_load_dword v188, v20, s[32:35], s62 offen offset:2048 sc1
  s_cmp_lg_u32 s59, 9
  s_cbranch_scc1 L_nc9
  s_mov_b64 exec, 1
  buffer_atomic_add v49, v13, s[44:47], 0 offen
  s_mov_b64 exec, -1
L_nc9:
  s_barrier
  s_cmp_lg_u32 s59, 10
  s_cbranch_scc1 L_nc10
  s_mov_b64 exec, 1
  buffer_atomic_add v49, v13, s[44:47], 0 offen
  s_mov_b64 exec, -1
L_nc10:
  s_barrier
  s_cmp_lg_u32 s59, 11
  s_cbranch_scc1 L_nc11
  s_mov_b64 exec, 1
  buffer_atomic_add v49, v13, s[44:47], 0 offen
  s_mov_b64 exec, -1
L_nc11:
  s_waitcnt vmcnt(9)
  s_barrier
  s_add_u32 m0, s27, 89600
  s_mov_b32 s62, 896
  buffer_load_dwordx4 v15, s[28:31], s62 offen lds
  s_add_u32 m0, s27, 92672
  s_mov_b32 s62, 28544
  buffer_load_dwordx4 v15, s[28:31], s62 offen lds
  s_add_u32 m0, s27, 95744
  s_mov_b32 s62, 56192
  buffer_load_dwordx4 v15, s[28:31], s62 offen lds
  s_add_u32 m0, s27, 98816
  s_mov_b32 s62, 83840
  buffer_load_dwordx4 v15, s[28:31], s62 offen lds
  s_cmp_lg_u32 s59, 12
  s_cbranch_scc1 L_nc12
  s_mov_b64 exec, 1
  buffer_atomic_add v49, v13, s[44:47], 0 offen
  s_mov_b64 exec, -1
L_nc12:
  s_barrier
  s_cmp_lg_u32 s59, 13
  s_cbranch_scc1 L_nc13
  s_mov_b64 exec, 1
  buffer_atomic_add v49, v13, s[44:47], 0 offen
  s_mov_b64 exec, -1
L_nc13:
  s_barrier
  s_add_u32 m0, s27, 38400
  s_mov_b32 s62, 384
  buffer_load_dwordx4 v15, s[28:31], s62 offen lds
  s_add_u32 m0, s27, 41472
  s_mov_b32 s62, 28032
  buffer_load_dwordx4 v15, s[28:31], s62 offen lds
  s_add_u32 m0, s27, 44544
  s_mov_b32 s62, 55680
  buffer_load_dwordx4 v15, s[28:31], s62 offen lds
  s_add_u32 m0, s27, 47616
  s_mov_b32 s62, 83328
  buffer_load_dwordx4 v15, s[28:31], s62 offen lds
  s_cmp_lg_u32 s59, 14
  s_cbranch_scc1 L_nc14
  s_mov_b64 exec, 1
  buffer_atomic_add v49, v13, s[44:47], 0 offen
  s_mov_b64 exec, -1
L_nc14:
  s_waitcnt vmcnt(4)
  s_barrier
  s_cmp_lg_u32 s59, 15
  s_cbranch_scc1 L_nc15
  s_mov_b64 exec, 1
  buffer_atomic_add v49, v13, s[44:47], 0 offen
  s_mov_b64 exec, -1
L_nc15:
  s_barrier
  s_add_u32 m0, s27, 102400
  s_mov_b32 s62, 1024
  buffer_load_dwordx4 v15, s[28:31], s62 offen lds
  s_add_u32 m0, s27, 105472
  s_mov_b32 s62, 28672
  buffer_load_dwordx4 v15, s[28:31], s62 offen lds
  s_add_u32 m0, s27, 108544
  s_mov_b32 s62, 56320
  buffer_load_dwordx4 v15, s[28:31], s62 offen lds
  s_add_u32 m0, s27, 111616
  s_mov_b32 s62, 83968
  buffer_load_dwordx4 v15, s[28:31], s62 offen lds
  s_cmp_lg_u32 s59, 16
  s_cbranch_scc1 L_nc16
  s_mov_b64 exec, 1
  buffer_atomic_add v49, v13, s[44:47], 0 offen
  s_mov_b64 exec, -1
L_nc16:
  s_waitcnt vmcnt(4)
  s_barrier
  s_barrier
  s_sub_u32 s58, s20, 4
  v_bfe_u32 v5, v1, 1, 2
  v_lshrrev_b32 v7, 4, v1
  v_mul_u32_u24 v6, 12, v5
  s_lshl_b32 s63, s58, 2
  v_add3_u32 v8, v6, v7, s63
  v_lshlrev_b32 v8, 1, v8
  v_add_u32 v52, s26, v8
  v_and_b32 v4, 7, v1
  v_lshlrev_b32 v4, 4, v4
  s_lshl_b32 s63, s58, 7
  v_lshl_add_u32 v42, v7, 2, v4
  s_add_u32 s64, s63, 162816
  v_add_u32 v42, s64, v42
  v_lshrrev_b32 v44, 3, v1
  v_mul_u32_u24 v44, 384, v44
  v_add3_u32 v44, v44, v4, s63
  s_mul_i32 s64, s24, 384
  s_add_u32 s64, s64, s63
  v_add_u32 v45, s64, v4
  s_add_u32 s64, s63, 161280
  v_add_u32 v46, s64, v4
  s_lshl_b32 s64, s58, 4
  s_add_u32 s64, s64, 163200
  v_mov_b32 v47, s64
  s_lshl_b32 s64, s58, 2
  s_add_u32 s64, s64, 163248
  v_mov_b32 v48, s64
  v_mov_b32 v49, 1
  v_mov_b32 v50, 0x39032fd1
  v_add_u32 v51, 16, v48
  v_and_b32 v4, 1, v1
  v_cmp_eq_u32 s[68:69], 1, v4
  s_waitcnt vmcnt(0)
  s_barrier
  buffer_load_ushort v40, v52, s[48:51], 0 offen
  buffer_load_ushort v41, v52, s[52:55], 0 offen
  s_barrier
  s_barrier
  s_barrier
  s_branch L_gather
.p2align 12
L_w6:
  s_mov_b32 s43, 0x20000
  s_mov_b32 s47, 0x20000
  s_mov_b32 s51, 0x20000
  s_mov_b32 s55, 0x20000
  s_mov_b32 s42, 16128
  s_mov_b32 s46, 256
  s_mov_b32 s50, 288
  s_mov_b32 s54, 288
  s_mul_i32 s65, s25, 16128
  s_add_u32 s40, s16, s65
  s_addc_u32 s41, s17, 0
  s_mov_b32 s44, s14
  s_mov_b32 s45, s15
  s_mov_b32 s48, s8
  s_mov_b32 s49, s9
  s_mov_b32 s52, s10
  s_mov_b32 s53, s11
  s_waitcnt vmcnt(11)
  s_barrier
  s_mov_b32 m0, 142848
  s_mov_b32 s62, 92160
  buffer_load_dwordx4 v10, s[32:35], s62 offen offset:0 lds
  buffer_load_dwordx4 v11, s[32:35], s62 offen offset:1024 lds
  buffer_load_dwordx4 v12, s[32:35], s62 offen offset:2048 lds
  s_waitcnt vmcnt(13)
  s_barrier
  s_mov_b32 m0, 148992
  s_mov_b32 s62, 258048
  buffer_load_dwordx4 v10, s[32:35], s62 offen offset:0 lds
  buffer_load_dwordx4 v11, s[32:35], s62 offen offset:1024 lds
  buffer_load_dwordx4 v12, s[32:35], s62 offen offset:2048 lds
  s_waitcnt vmcnt(15)
  s_barrier
  s_mov_b32 m0, 155136
  s_mov_b32 s62, 423936
  buffer_load_dwordx4 v10, s[32:35], s62 offen offset:0 lds
  buffer_load_dwordx4 v11, s[32:35], s62 offen offset:1024 lds
  buffer_load_dwordx4 v12, s[32:35], s62 offen offset:2048 lds
  s_waitcnt vmcnt(12)
  s_barrier
  s_mov_b32 m0, 115200
  s_mov_b32 s62, 589824
  buffer_load_dwordx4 v10, s[32:35], s62 offen offset:0 lds
  buffer_load_dwordx4 v11, s[32:35], s62 offen offset:1024 lds
  buffer_load_dwordx4 v12, s[32:35], s62 offen offset:2048 lds
  s_waitcnt vmcnt(12)
  s_barrier
  s_mov_b32 m0, 121344
  s_mov_b32 s62, 101376
  buffer_load_dwordx4 v10, s[32:35], s62 offen offset:0 lds
  buffer_load_dwordx4 v11, s[32:35], s62 offen offset:1024 lds
  buffer_load_dwordx4 v12, s[32:35], s62 offen offset:2048 lds
  s_mov_b32 m0, 127488
  s_mov_b32 s62, 267264
  buffer_load_dwordx4 v10, s[32:35], s62 offen offset:0 lds
  buffer_load_dwordx4 v11, s[32:35], s62 offen offset:1024 lds
  buffer_load_dwordx4 v12, s[32:35], s62 offen offset:2048 lds
  s_waitcnt vmcnt(12)
  s_barrier
  s_mov_b32 m0, 133632
  s_mov_b32 s62, 433152
  buffer_load_dwordx4 v10, s[32:35], s62 offen offset:0 lds
  buffer_load_dwordx4 v11, s[32:35], s62 offen offset:1024 lds
  buffer_load_dwordx4 v12, s[32:35], s62 offen offset:2048 lds
  s_waitcnt vmcnt(12)
  s_barrier
  s_mov_b32 m0, 139776
  s_mov_b32 s62, 599040
  buffer_load_dwordx4 v10, s[32:35], s62 offen offset:0 lds
  buffer_load_dwordx4 v11, s[32:35], s62 offen offset:1024 lds
  buffer_load_dwordx4 v12, s[32:35], s62 offen offset:2048 lds
  s_mov_b32 m0, 145920
  s_mov_b32 s62, 110592
  buffer_load_dwordx4 v10, s[32:35], s62 offen offset:0 lds
  buffer_load_dwordx4 v11, s[32:35], s62 offen offset:1024 lds
  buffer_load_dwordx4 v12, s[32:35], s62 offen offset:2048 lds
  s_waitcnt vmcnt(12)
  s_barrier
  s_mov_b32 m0, 152064
  s_mov_b32 s62, 276480
  buffer_load_dwordx4 v10, s[32:35], s62 offen offset:0 lds
  buffer_load_dwordx4 v11, s[32:35], s62 offen offset:1024 lds
  buffer_load_dwordx4 v12, s[32:35], s62 offen offset:2048 lds
  s_waitcnt vmcnt(12)
  s_barrier
  s_mov_b32 m0, 158208
  s_mov_b32 s62, 442368
  buffer_load_dwordx4 v10, s[32:35], s62 offen offset:0 lds
  buffer_load_dwordx4 v11, s[32:35], s62 offen offset:1024 lds
  buffer_load_dwordx4 v12, s[32:35], s62 offen offset:2048 lds
  s_mov_b32 m0, 118272
  s_mov_b32 s62, 608256
  buffer_load_dwordx4 v10, s[32:35], s62 offen offset:0 lds
  buffer_load_dwordx4 v11, s[32:35], s62 offen offset:1024 lds
  buffer_load_dwordx4 v12, s[32:35], s62 offen offset:2048 lds
  s_waitcnt vmcnt(12)
  s_barrier
  s_mov_b32 m0, 124416
  s_mov_b32 s62, 119808
  buffer_load_dwordx4 v10, s[32:35], s62 offen offset:0 lds
  buffer_load_dwordx4 v11, s[32:35], s62 offen offset:1024 lds
  buffer_load_dwordx4 v12, s[32:35], s62 offen offset:2048 lds
  s_waitcnt vmcnt(12)
  s_barrier
  s_mov_b32 m0, 130560
  s_mov_b32 s62, 285696
  buffer_load_dwordx4 v10, s[32:35], s62 offen offset:0 lds
  buffer_load_dwordx4 v11, s[32:35], s62 offen offset:1024 lds
  buffer_load_dwordx4 v12, s[32:35], s62 offen offset:2048 lds
  s_mov_b32 m0, 136704
  s_mov_b32 s62, 451584
  buffer_load_dwordx4 v10, s[32:35], s62 offen offset:0 lds
  buffer_load_dwordx4 v11, s[32:35], s62 offen offset:1024 lds
  buffer_load_dwordx4 v12, s[32:35], s62 offen offset:2048 lds
  s_waitcnt vmcnt(12)
  s_barrier
  s_mov_b32 m0, 142848
  s_mov_b32 s62, 617472
  buffer_load_dwordx4 v10, s[32:35], s62 offen offset:0 lds
  buffer_load_dwordx4 v11, s[32:35], s62 offen offset:1024 lds
  buffer_load_dwordx4 v12, s[32:35], s62 offen offset:2048 lds
  s_waitcnt vmcnt(12)
  s_barrier
  s_mov_b32 m0, 148992
  s_mov_b32 s62, 129024
  buffer_load_dwordx4 v10, s[32:35], s62 offen offset:0 lds
  buffer_load_dwordx4 v11, s[32:35], s62 offen offset:1024 lds
  buffer_load_dwordx4 v12, s[32:35], s62 offen offset:2048 lds
  s_mov_b32 m0, 155136
  s_mov_b32 s62, 294912
  buffer_load_dwordx4 v10, s[32:35], s62 offen offset:0 lds
  buffer_load_dwordx4 v11, s[32:35], s62 offen offset:1024 lds
  buffer_load_dwordx4 v12, s[32:35], s62 offen offset:2048 lds
  s_waitcnt vmcnt(12)
  s_barrier
  s_mov_b32 m0, 115200
  s_mov_b32 s62, 460800
  buffer_load_dwordx4 v10, s[32:35], s62 offen offset:0 lds
  buffer_load_dwordx4 v11, s[32:35], s62 offen offset:1024 lds
  buffer_load_dwordx4 v12, s[32:35], s62 offen offset:2048 lds
  s_waitcnt vmcnt(12)
  s_barrier
  s_mov_b32 m0, 121344
  s_mov_b32 s62, 55296
  buffer_load_dwordx4 v10, s[32:35], s62 offen offset:0 lds
  buffer_load_dwordx4 v11, s[32:35], s62 offen offset:1024 lds
  buffer_load_dwordx4 v12, s[32:35], s62 offen offset:2048 lds
  s_mov_b32 m0, 127488
  s_mov_b32 s62, 221184
  buffer_load_dwordx4 v10, s[32:35], s62 offen offset:0 lds
  buffer_load_dwordx4 v11, s[32:35], s62 offen offset:1024 lds
  buffer_load_dwordx4 v12, s[32:35], s62 offen offset:2048 lds
  s_waitcnt vmcnt(12)
  s_barrier
  s_mov_b32 m0, 133632
  s_mov_b32 s62, 387072
  buffer_load_dwordx4 v10, s[32:35], s62 offen offset:0 lds
  buffer_load_dwordx4 v11, s[32:35], s62 offen offset:1024 lds
  buffer_load_dwordx4 v12, s[32:35], s62 offen offset:2048 lds
  s_waitcnt vmcnt(12)
  s_barrier
  s_mov_b32 m0, 139776
  s_mov_b32 s62, 552960
  buffer_load_dwordx4 v10, s[32:35], s62 offen offset:0 lds
  buffer_load_dwordx4 v11, s[32:35], s62 offen offset:1024 lds
  buffer_load_dwordx4 v12, s[32:35], s62 offen offset:2048 lds
  s_mov_b32 m0, 145920
  s_mov_b32 s62, 147456
  buffer_load_dwordx4 v10, s[32:35], s62 offen offset:0 lds
  buffer_load_dwordx4 v11, s[32:35], s62 offen offset:1024 lds
  buffer_load_dwordx4 v12, s[32:35], s62 offen offset:2048 lds
  s_waitcnt vmcnt(12)
  s_barrier
  s_mov_b32 m0, 152064
  s_mov_b32 s62, 313344
  buffer_load_dwordx4 v10, s[32:35], s62 offen offset:0 lds
  buffer_load_dwordx4 v11, s[32:35], s62 offen offset:1024 lds
  buffer_load_dwordx4 v12, s[32:35], s62 offen offset:2048 lds
  s_waitcnt vmcnt(12)
  s_barrier
  s_mov_b32 m0, 158208
  s_mov_b32 s62, 479232
  buffer_load_dwordx4 v10, s[32:35], s62 offen offset:0 lds
  buffer_load_dwordx4 v11, s[32:35], s62 offen offset:1024 lds
  buffer_load_dwordx4 v12, s[32:35], s62 offen offset:2048 lds
  s_waitcnt vmcnt(9)
  s_barrier
  s_mov_b32 m0, 118272
  s_mov_b32 s62, 73728
  buffer_load_dwordx4 v10, s[32:35], s62 offen offset:0 lds
  buffer_load_dwordx4 v11, s[32:35], s62 offen offset:1024 lds
  buffer_load_dwordx4 v12, s[32:35], s62 offen offset:2048 lds
  s_mov_b32 m0, 124416
  s_mov_b32 s62, 239616
  buffer_load_dwordx4 v10, s[32:35], s62 offen offset:0 lds
  buffer_load_dwordx4 v11, s[32:35], s62 offen offset:1024 lds
  buffer_load_dwordx4 v12, s[32:35], s62 offen offset:2048 lds
  s_waitcnt vmcnt(12)
  s_barrier
  s_mov_b32 m0, 130560
  s_mov_b32 s62, 405504
  buffer_load_dwordx4 v10, s[32:35], s62 offen offset:0 lds
  buffer_load_dwordx4 v11, s[32:35], s62 offen offset:1024 lds
  buffer_load_dwordx4 v12, s[32:35], s62 offen offset:2048 lds
  s_mov_b32 m0, 136704
  s_mov_b32 s62, 571392
  buffer_load_dwordx4 v10, s[32:35], s62 offen offset:0 lds
  buffer_load_dwordx4 v11, s[32:35], s62 offen offset:1024 lds
  buffer_load_dwordx4 v12, s[32:35], s62 offen offset:2048 lds
  s_sub_u32 s58, s20, 4
  v_bfe_u32 v5, v1, 1, 2
  v_lshrrev_b32 v7, 4, v1
  v_mul_u32_u24 v6, 12, v5
  s_lshl_b32 s63, s58, 2
  v_add3_u32 v8, v6, v7, s63
  v_lshlrev_b32 v8, 1, v8
  v_add_u32 v52, s26, v8
  v_and_b32 v4, 7, v1
  v_lshlrev_b32 v4, 4, v4
  s_lshl_b32 s63, s58, 7
  v_lshl_add_u32 v42, v7, 2, v4
  s_add_u32 s64, s63, 162816
  v_add_u32 v42, s64, v42
  v_lshrrev_b32 v44, 3, v1
  v_mul_u32_u24 v44, 384, v44
  v_add3_u32 v44, v44, v4, s63
  s_mul_i32 s64, s24, 384
  s_add_u32 s64, s64, s63
  v_add_u32 v45, s64, v4
  s_add_u32 s64, s63, 161280
  v_add_u32 v46, s64, v4
  s_lshl_b32 s64, s58, 4
  s_add_u32 s64, s64, 163200
  v_mov_b32 v47, s64
  s_lshl_b32 s64, s58, 2
  s_add_u32 s64, s64, 163248
  v_mov_b32 v48, s64
  v_mov_b32 v49, 1
  v_mov_b32 v50, 0x39032fd1
  v_add_u32 v51, 16, v48
  v_and_b32 v4, 1, v1
  v_cmp_eq_u32 s[68:69], 1, v4
  s_waitcnt vmcnt(12)
  s_barrier
  buffer_load_ushort v40, v52, s[48:51], 0 offen
  buffer_load_ushort v41, v52, s[52:55], 0 offen
  s_waitcnt vmcnt(2)
  s_barrier
  s_branch L_gather
.p2align 12
L_w7:
  s_lshl_b32 s63, s25, 11
  s_add_u32 s63, s63, 98304
  s_add_u32 s40, s16, s63
  s_addc_u32 s41, s17, 0
  s_movk_i32 s42, 2048
  v_lshlrev_b32 v16, 7, v1
  s_lshl_b32 s63, s60, 7
  v_mov_b32 v17, 0
  s_mov_b32 s43, 0x20000
  s_mov_b32 s44, s14
  s_mov_b32 s45, s15
  s_mov_b32 s46, 256
  s_mov_b32 s47, 0x20000
  s_lshl_b32 s63, s22, 5
  s_lshl_b32 s64, s23, 7
  s_add_u32 s63, s63, s64
  v_mov_b32 v14, s63
  v_mov_b32 v15, 0
  v_mov_b32 v31, 1
  v_mov_b32 v33, 1
  v_mov_b32 v34, 163260
  s_waitcnt vmcnt(9)
  s_barrier
  s_barrier
  s_mov_b32 m0, 145920
  s_mov_b32 s62, 175104
  buffer_load_dwordx4 v10, s[32:35], s62 offen offset:0 lds
  buffer_load_dwordx4 v11, s[32:35], s62 offen offset:1024 lds
  buffer_load_dwordx4 v12, s[32:35], s62 offen offset:2048 lds
  s_barrier
  s_mov_b32 m0, 152064
  s_mov_b32 s62, 340992
  buffer_load_dwordx4 v10, s[32:35], s62 offen offset:0 lds
  buffer_load_dwordx4 v11, s[32:35], s62 offen offset:1024 lds
  buffer_load_dwordx4 v12, s[32:35], s62 offen offset:2048 lds
  s_waitcnt vmcnt(12)
  s_barrier
  s_mov_b32 m0, 158208
  s_mov_b32 s62, 506880
  buffer_load_dwordx4 v10, s[32:35], s62 offen offset:0 lds
  buffer_load_dwordx4 v11, s[32:35], s62 offen offset:1024 lds
  buffer_load_dwordx4 v12, s[32:35], s62 offen offset:2048 lds
  s_mov_b32 m0, 118272
  s_mov_b32 s62, 18432
  buffer_load_dwordx4 v10, s[32:35], s62 offen offset:0 lds
  buffer_load_dwordx4 v11, s[32:35], s62 offen offset:1024 lds
  buffer_load_dwordx4 v12, s[32:35], s62 offen offset:2048 lds
  s_waitcnt vmcnt(12)
  s_barrier
  buffer_load_dword v30, v15, s[40:43], 0 offen sc1
  s_mov_b32 m0, 124416
  s_mov_b32 s62, 184320
  buffer_load_dwordx4 v10, s[32:35], s62 offen offset:0 lds
  buffer_load_dwordx4 v11, s[32:35], s62 offen offset:1024 lds
  buffer_load_dwordx4 v12, s[32:35], s62 offen offset:2048 lds
  s_waitcnt vmcnt(13)
  s_barrier
  s_mov_b32 m0, 130560
  s_mov_b32 s62, 350208
  buffer_load_dwordx4 v10, s[32:35], s62 offen offset:0 lds
  buffer_load_dwordx4 v11, s[32:35], s62 offen offset:1024 lds
  buffer_load_dwordx4 v12, s[32:35], s62 offen offset:2048 lds
  s_mov_b32 m0, 136704
  s_mov_b32 s62, 516096
  buffer_load_dwordx4 v10, s[32:35], s62 offen offset:0 lds
  buffer_load_dwordx4 v11, s[32:35], s62 offen offset:1024 lds
  buffer_load_dwordx4 v12, s[32:35], s62 offen offset:2048 lds
  s_waitcnt vmcnt(13)
  s_barrier
  s_mov_b32 m0, 142848
  s_mov_b32 s62, 27648
  buffer_load_dwordx4 v10, s[32:35], s62 offen offset:0 lds
  buffer_load_dwordx4 v11, s[32:35], s62 offen offset:1024 lds
  buffer_load_dwordx4 v12, s[32:35], s62 offen offset:2048 lds
  s_waitcnt vmcnt(13)
  s_barrier
  s_mov_b32 m0, 148992
  s_mov_b32 s62, 193536
  buffer_load_dwordx4 v10, s[32:35], s62 offen offset:0 lds
  buffer_load_dwordx4 v11, s[32:35], s62 offen offset:1024 lds
  buffer_load_dwordx4 v12, s[32:35], s62 offen offset:2048 lds
  s_mov_b32 m0, 155136
  s_mov_b32 s62, 359424
  buffer_load_dwordx4 v10, s[32:35], s62 offen offset:0 lds
  buffer_load_dwordx4 v11, s[32:35], s62 offen offset:1024 lds
  buffer_load_dwordx4 v12, s[32:35], s62 offen offset:2048 lds
  s_waitcnt vmcnt(12)
  s_barrier
  s_mov_b32 m0, 115200
  s_mov_b32 s62, 525312
  buffer_load_dwordx4 v10, s[32:35], s62 offen offset:0 lds
  buffer_load_dwordx4 v11, s[32:35], s62 offen offset:1024 lds
  buffer_load_dwordx4 v12, s[32:35], s62 offen offset:2048 lds
  s_waitcnt vmcnt(12)
  s_barrier
  s_mov_b32 m0, 121344
  s_mov_b32 s62, 36864
  buffer_load_dwordx4 v10, s[32:35], s62 offen offset:0 lds
  buffer_load_dwordx4 v11, s[32:35], s62 offen offset:1024 lds
  buffer_load_dwordx4 v12, s[32:35], s62 offen offset:2048 lds
  s_mov_b32 m0, 127488
  s_mov_b32 s62, 202752
  buffer_load_dwordx4 v10, s[32:35], s62 offen offset:0 lds
  buffer_load_dwordx4 v11, s[32:35], s62 offen offset:1024 lds
  buffer_load_dwordx4 v12, s[32:35], s62 offen offset:2048 lds
  s_waitcnt vmcnt(12)
  s_barrier
  s_mov_b32 m0, 133632
  s_mov_b32 s62, 368640
  buffer_load_dwordx4 v10, s[32:35], s62 offen offset:0 lds
  buffer_load_dwordx4 v11, s[32:35], s62 offen offset:1024 lds
  buffer_load_dwordx4 v12, s[32:35], s62 offen offset:2048 lds
  s_waitcnt vmcnt(12)
  s_barrier
  s_mov_b32 m0, 139776
  s_mov_b32 s62, 534528
  buffer_load_dwordx4 v10, s[32:35], s62 offen offset:0 lds
  buffer_load_dwordx4 v11, s[32:35], s62 offen offset:1024 lds
  buffer_load_dwordx4 v12, s[32:35], s62 offen offset:2048 lds
  s_mov_b32 m0, 145920
  s_mov_b32 s62, 46080
  buffer_load_dwordx4 v10, s[32:35], s62 offen offset:0 lds
  buffer_load_dwordx4 v11, s[32:35], s62 offen offset:1024 lds
  buffer_load_dwordx4 v12, s[32:35], s62 offen offset:2048 lds
  s_waitcnt vmcnt(12)
  s_barrier
  s_mov_b32 m0, 152064
  s_mov_b32 s62, 211968
  buffer_load_dwordx4 v10, s[32:35], s62 offen offset:0 lds
  buffer_load_dwordx4 v11, s[32:35], s62 offen offset:1024 lds
  buffer_load_dwordx4 v12, s[32:35], s62 offen offset:2048 lds
  s_waitcnt vmcnt(12)
  s_barrier
  s_mov_b32 m0, 158208
  s_mov_b32 s62, 377856
  buffer_load_dwordx4 v10, s[32:35], s62 offen offset:0 lds
  buffer_load_dwordx4 v11, s[32:35], s62 offen offset:1024 lds
  buffer_load_dwordx4 v12, s[32:35], s62 offen offset:2048 lds
  s_mov_b32 m0, 118272
  s_mov_b32 s62, 543744
  buffer_load_dwordx4 v10, s[32:35], s62 offen offset:0 lds
  buffer_load_dwordx4 v11, s[32:35], s62 offen offset:1024 lds
  buffer_load_dwordx4 v12, s[32:35], s62 offen offset:2048 lds
  s_waitcnt vmcnt(12)
  s_barrier
  s_mov_b32 m0, 124416
  s_mov_b32 s62, 138240
  buffer_load_dwordx4 v10, s[32:35], s62 offen offset:0 lds
  buffer_load_dwordx4 v11, s[32:35], s62 offen offset:1024 lds
  buffer_load_dwordx4 v12, s[32:35], s62 offen offset:2048 lds
  s_waitcnt vmcnt(12)
  s_barrier
  s_mov_b32 m0, 130560
  s_mov_b32 s62, 304128
  buffer_load_dwordx4 v10, s[32:35], s62 offen offset:0 lds
  buffer_load_dwordx4 v11, s[32:35], s62 offen offset:1024 lds
  buffer_load_dwordx4 v12, s[32:35], s62 offen offset:2048 lds
  s_mov_b32 m0, 136704
  s_mov_b32 s62, 470016
  buffer_load_dwordx4 v10, s[32:35], s62 offen offset:0 lds
  buffer_load_dwordx4 v11, s[32:35], s62 offen offset:1024 lds
  buffer_load_dwordx4 v12, s[32:35], s62 offen offset:2048 lds
  s_waitcnt vmcnt(12)
  s_barrier
  s_mov_b32 m0, 142848
  s_mov_b32 s62, 64512
  buffer_load_dwordx4 v10, s[32:35], s62 offen offset:0 lds
  buffer_load_dwordx4 v11, s[32:35], s62 offen offset:1024 lds
  buffer_load_dwordx4 v12, s[32:35], s62 offen offset:2048 lds
  s_waitcnt vmcnt(12)
  s_barrier
  s_mov_b32 m0, 148992
  s_mov_b32 s62, 230400
  buffer_load_dwordx4 v10, s[32:35], s62 offen offset:0 lds
  buffer_load_dwordx4 v11, s[32:35], s62 offen offset:1024 lds
  buffer_load_dwordx4 v12, s[32:35], s62 offen offset:2048 lds
  s_mov_b32 m0, 155136
  s_mov_b32 s62, 396288
  buffer_load_dwordx4 v10, s[32:35], s62 offen offset:0 lds
  buffer_load_dwordx4 v11, s[32:35], s62 offen offset:1024 lds
  buffer_load_dwordx4 v12, s[32:35], s62 offen offset:2048 lds
  s_waitcnt vmcnt(12)
  s_barrier
  s_mov_b32 m0, 115200
  s_mov_b32 s62, 562176
  buffer_load_dwordx4 v10, s[32:35], s62 offen offset:0 lds
  buffer_load_dwordx4 v11, s[32:35], s62 offen offset:1024 lds
  buffer_load_dwordx4 v12, s[32:35], s62 offen offset:2048 lds
  s_waitcnt vmcnt(12)
  s_barrier
  s_mov_b32 m0, 121344
  s_mov_b32 s62, 156672
  buffer_load_dwordx4 v10, s[32:35], s62 offen offset:0 lds
  buffer_load_dwordx4 v11, s[32:35], s62 offen offset:1024 lds
  buffer_load_dwordx4 v12, s[32:35], s62 offen offset:2048 lds
  s_mov_b32 m0, 127488
  s_mov_b32 s62, 322560
  buffer_load_dwordx4 v10, s[32:35], s62 offen offset:0 lds
  buffer_load_dwordx4 v11, s[32:35], s62 offen offset:1024 lds
  buffer_load_dwordx4 v12, s[32:35], s62 offen offset:2048 lds
  s_waitcnt vmcnt(12)
  s_barrier
  s_mov_b32 m0, 133632
  s_mov_b32 s62, 488448
  buffer_load_dwordx4 v10, s[32:35], s62 offen offset:0 lds
  buffer_load_dwordx4 v11, s[32:35], s62 offen offset:1024 lds
  buffer_load_dwordx4 v12, s[32:35], s62 offen offset:2048 lds
  s_waitcnt vmcnt(9)
  s_barrier
  s_mov_b64 exec, 1
  buffer_atomic_add v31, v15, s[40:43], 0 offen sc0
  s_mov_b64 exec, -1
  buffer_load_dword v32, v14, s[44:47], 0 offen sc1
  s_waitcnt vmcnt(2)
  s_barrier
  s_waitcnt vmcnt(0)
  s_mov_b32 s62, 0
  v_readfirstlane_b32 s63, v30
  v_readfirstlane_b32 s64, v31
  s_add_u32 s65, s63, 0x5bd1e995
  s_sub_u32 s64, s64, s63
  s_cmp_lg_u32 s64, 41
  s_cbranch_scc1 L_gp
  v_mov_b32 v35, s65
  s_mov_b64 exec, 1
  buffer_store_dword v35, v16, s[40:43], 0 offen offset:128 sc1
  s_mov_b64 exec, -1
  s_branch L_gd
L_gp:
  buffer_load_dword v35, v17, s[40:43], 0 offen offset:128 sc1
  s_add_u32 s62, s62, 1
  s_waitcnt vmcnt(0)
  v_readfirstlane_b32 s63, v35
  s_cmp_eq_u32 s63, s65
  s_cbranch_scc1 L_gd
  s_sleep 2
  s_cmp_lt_u32 s62, 24
  s_cbranch_scc1 L_gp
L_gd:
  s_mov_b32 s58, 0
  v_readfirstlane_b32 s63, v32
  s_cmp_ge_u32 s63, 42
  s_cbranch_scc1 L_cdone
L_cpoll:
  s_sleep 4
  buffer_load_dword v32, v14, s[44:47], 0 offen sc1
  s_add_u32 s58, s58, 1
  s_waitcnt vmcnt(0)
  v_readfirstlane_b32 s63, v32
  s_cmp_ge_u32 s63, 42
  s_cbranch_scc1 L_cdone
  s_cmp_lt_u32 s58, 0x40000
  s_cbranch_scc1 L_cpoll
L_cdone:
  s_sleep 7
  ds_write_b32 v34, v33 offset:4
  s_sleep 7
  ds_write_b32 v34, v33 offset:8
  s_sleep 6
  ds_write_b32 v34, v33 offset:12
  s_endpgm
.p2align 6
L_gh:
  s_branch L_wr
L_gather:
  s_mul_i32 s62, s58, 6
  s_add_u32 s62, s62, 9
L_gs:
  s_sleep 1
  s_sub_u32 s62, s62, 1
  s_cbranch_scc0 L_gs
  s_setprio 1
  s_waitcnt vmcnt(0)
  v_lshlrev_b32 v40, 16, v40
  v_lshlrev_b32 v41, 16, v41
  s_mov_b32 s64, 6144
  s_mov_b32 s65, 12288
  s_mov_b64 exec, 0xff
L_pw:
  ds_read_b128 v[16:19], v47
  ds_read_b128 v[20:23], v46
  ds_read_b128 v[24:27], v46 offset:384
  ds_read_b128 v[28:31], v46 offset:768
  ds_read_b128 v[32:35], v46 offset:1152
  s_waitcnt lgkmcnt(4)
  v_and_b32 v16, v16, v17
  v_and_b32 v18, v18, v19
  v_and_b32 v16, v16, v18
  s_nop 0
  v_readfirstlane_b32 s63, v16
  s_cmp_lg_u32 s63, 0
  s_cbranch_scc1 L_pwd
  s_sleep 0
  s_branch L_pw
L_pwd:
  s_waitcnt lgkmcnt(0)
  v_pk_add_f32 v[20:21], v[20:21], v[24:25]
  v_pk_add_f32 v[22:23], v[22:23], v[26:27]
  v_pk_add_f32 v[28:29], v[28:29], v[32:33]
  v_pk_add_f32 v[30:31], v[30:31], v[34:35]
  v_pk_add_f32 v[20:21], v[20:21], v[28:29]
  v_pk_add_f32 v[22:23], v[22:23], v[30:31]
  buffer_store_dwordx4 v[20:23], v45, s[40:43], 0 offen sc1
  s_mov_b64 s[84:85], -1
  s_mov_b64 s[86:87], -1
  s_mov_b64 s[88:89], -1
  s_mov_b64 s[90:91], -1
  s_mov_b64 s[92:93], -1
  s_mov_b64 s[94:95], -1
  s_sleep 6
  s_mov_b32 s62, 0
L_gw:
  ds_read_b32 v36, v51
  s_waitcnt lgkmcnt(0)
  v_readfirstlane_b32 s63, v36
  s_cmp_eq_u32 s63, 0
  s_cbranch_scc1 L_gw
  s_mov_b64 exec, -1
  buffer_load_dwordx4 v[16:19], v44, s[40:43], 0 offen offset:0 sc1
  buffer_load_dwordx4 v[20:23], v44, s[40:43], 0 offen offset:3072 sc1
  buffer_load_dwordx4 v[24:27], v44, s[40:43], s64 offen offset:0 sc1
  buffer_load_dwordx4 v[28:31], v44, s[40:43], s64 offen offset:3072 sc1
  buffer_load_dwordx4 v[32:35], v44, s[40:43], s65 offen offset:0 sc1
  buffer_load_dwordx4 v[36:39], v44, s[40:43], s65 offen offset:3072 sc1
  s_mov_b32 s62, 1
  s_waitcnt vmcnt(4)
  v_max3_u32 v43, v16, v17, v18
  v_max3_u32 v53, v19, v20, v21
  v_pk_add_f32 v[56:57], v[16:17], v[20:21]
  v_max3_u32 v43, v43, v22, v23
  v_pk_add_f32 v[58:59], v[18:19], v[22:23]
  s_waitcnt vmcnt(2)
  v_max3_u32 v53, v53, v24, v25
  v_max3_u32 v43, v43, v26, v27
  v_pk_add_f32 v[62:63], v[24:25], v[28:29]
  v_max3_u32 v53, v53, v28, v29
  v_pk_add_f32 v[54:55], v[26:27], v[30:31]
  v_max3_u32 v43, v43, v30, v31
  v_pk_add_f32 v[56:57], v[56:57], v[62:63]
  v_pk_add_f32 v[58:59], v[58:59], v[54:55]
  s_waitcnt vmcnt(0)
  v_max3_u32 v53, v53, v32, v33
  v_max3_u32 v43, v43, v34, v35
  v_max3_u32 v53, v53, v36, v37
  v_max3_u32 v43, v43, v38, v39
  v_pk_add_f32 v[62:63], v[32:33], v[36:37]
  v_max_u32 v43, v43, v53
  v_pk_add_f32 v[54:55], v[34:35], v[38:39]
  v_cmp_eq_u32 vcc, -1, v43
  v_pk_add_f32 v[56:57], v[56:57], v[62:63]
  v_pk_add_f32 v[58:59], v[58:59], v[54:55]
  s_cbranch_vccz L_red
  s_branch L_chk
L_poll:
  s_mov_b64 exec, s[84:85]
  s_cbranch_execz L_pl0
  buffer_load_dwordx4 v[16:19], v44, s[40:43], 0 offen offset:0 sc1
L_pl0:
  s_mov_b64 exec, s[86:87]
  s_cbranch_execz L_pl1
  buffer_load_dwordx4 v[20:23], v44, s[40:43], 0 offen offset:3072 sc1
L_pl1:
  s_mov_b64 exec, s[88:89]
  s_cbranch_execz L_pl2
  buffer_load_dwordx4 v[24:27], v44, s[40:43], s64 offen offset:0 sc1
L_pl2:
  s_mov_b64 exec, s[90:91]
  s_cbranch_execz L_pl3
  buffer_load_dwordx4 v[28:31], v44, s[40:43], s64 offen offset:3072 sc1
L_pl3:
  s_mov_b64 exec, s[92:93]
  s_cbranch_execz L_pl4
  buffer_load_dwordx4 v[32:35], v44, s[40:43], s65 offen offset:0 sc1
L_pl4:
  s_mov_b64 exec, s[94:95]
  s_cbranch_execz L_pl5
  buffer_load_dwordx4 v[36:39], v44, s[40:43], s65 offen offset:3072 sc1
L_pl5:
  s_add_u32 s62, s62, 1
  s_waitcnt vmcnt(0)
L_chk:
  s_mov_b64 exec, s[84:85]
  s_cbranch_execz L_pc0
  v_max3_u32 v43, v16, v17, v18
  v_max_u32 v43, v43, v19
  v_cmp_eq_u32 s[84:85], -1, v43
L_pc0:
  s_mov_b64 exec, s[86:87]
  s_cbranch_execz L_pc1
  v_max3_u32 v43, v20, v21, v22
  v_max_u32 v43, v43, v23
  v_cmp_eq_u32 s[86:87], -1, v43
L_pc1:
  s_mov_b64 exec, s[88:89]
  s_cbranch_execz L_pc2
  v_max3_u32 v43, v24, v25, v26
  v_max_u32 v43, v43, v27
  v_cmp_eq_u32 s[88:89], -1, v43
L_pc2:
  s_mov_b64 exec, s[90:91]
  s_cbranch_execz L_pc3
  v_max3_u32 v43, v28, v29, v30
  v_max_u32 v43, v43, v31
  v_cmp_eq_u32 s[90:91], -1, v43
L_pc3:
  s_mov_b64 exec, s[92:93]
  s_cbranch_execz L_pc4
  v_max3_u32 v43, v32, v33, v34
  v_max_u32 v43, v43, v35
  v_cmp_eq_u32 s[92:93], -1, v43
L_pc4:
  s_mov_b64 exec, s[94:95]
  s_cbranch_execz L_pc5
  v_max3_u32 v43, v36, v37, v38
  v_max_u32 v43, v43, v39
  v_cmp_eq_u32 s[94:95], -1, v43
L_pc5:
  s_or_b64 s[66:67], s[84:85], s[86:87]
  s_or_b64 s[66:67], s[66:67], s[88:89]
  s_or_b64 s[66:67], s[66:67], s[90:91]
  s_or_b64 s[66:67], s[66:67], s[92:93]
  s_or_b64 s[66:67], s[66:67], s[94:95]
  s_cbranch_scc0 L_pdone
  s_sleep 2
  s_cmp_lt_u32 s62, 0x40000
  s_cbranch_scc1 L_poll
L_pdone:
  s_mov_b64 exec, -1
  v_pk_add_f32 v[56:57], v[16:17], v[20:21]
  v_pk_add_f32 v[58:59], v[18:19], v[22:23]
  v_pk_add_f32 v[62:63], v[24:25], v[28:29]
  v_pk_add_f32 v[54:55], v[26:27], v[30:31]
  v_pk_add_f32 v[56:57], v[56:57], v[62:63]
  v_pk_add_f32 v[58:59], v[58:59], v[54:55]
  v_pk_add_f32 v[62:63], v[32:33], v[36:37]
  v_pk_add_f32 v[54:55], v[34:35], v[38:39]
  v_pk_add_f32 v[56:57], v[56:57], v[62:63]
  v_pk_add_f32 v[58:59], v[58:59], v[54:55]
L_red:
  s_nop 1
  v_permlane32_swap_b32 v56, v58
  v_permlane32_swap_b32 v57, v59
  v_add_f32 v16, v56, v58
  v_add_f32 v17, v57, v59
  s_nop 1
  v_permlane16_swap_b32 v16, v17
  v_add_f32 v16, v16, v17
  s_nop 1
  v_add_f32_dpp v16, v16, v16 row_ror:8 row_mask:0xf bank_mask:0xf
  s_nop 1
  v_mul_f32_dpp v17, v16, v50 quad_perm:[0,0,2,2] row_mask:0xf bank_mask:0xf
  v_mul_f32_dpp v20, v16, v50 quad_perm:[1,1,3,3] row_mask:0xf bank_mask:0xf
  v_fma_f32 v20, -v17, v17, v20
  v_max_f32 v20, 0, v20
  v_add_f32 v20, 0x3727c5ac, v20
  v_rsq_f32 v20, v20
  s_nop 0
  v_mul_f32 v20, v20, v40
  v_fma_f32 v21, -v17, v20, v41
  v_cndmask_b32 v20, v20, v21, s[68:69]
  ds_write_b32 v42, v20
  ds_write_b32 v48, v49
L_end:
  s_endpgm
L_codeend:
.section .rodata,"a"
.p2align 6
.amdhsa_kernel standalone__self_sup_conv_stem_wavlm__speech_kernel
  .amdhsa_next_free_vgpr 192
  .amdhsa_next_free_sgpr 102
  .amdhsa_accum_offset 192
  .amdhsa_group_segment_fixed_size 0
  .amdhsa_kernarg_size 56
  .amdhsa_user_sgpr_count 2
  .amdhsa_user_sgpr_kernarg_segment_ptr 1
  .amdhsa_system_sgpr_workgroup_id_x 1
.end_amdhsa_kernel
```
